```python
import torch

def _softmax(x, axis=-1):
    return torch.softmax(x, dim=axis)
def _gelu(x):
    return torch.nn.functional.gelu(x, approximate="tanh")
def _silu(x):
    return torch.nn.functional.silu(x)
def _sigmoid(x):
    return torch.sigmoid(x)
def _layernorm(x, axis=-1, eps=1e-5):
    m = x.mean(dim=axis, keepdim=True)
    v = x.var(dim=axis, keepdim=True, unbiased=False)
    return (x - m) / torch.sqrt(v + eps)
def _scatter_add(tgt, idx, src, axis=0):
    return tgt.clone().index_add_(axis, idx, src)
def _segment_sum(src, seg, n):
    out = torch.zeros((n,) + src.shape[1:], dtype=src.dtype)
    return out.index_add_(0, seg, src)
def _pad(x, pw):
    flat = tuple(v for pair in reversed(pw) for v in pair)
    return torch.nn.functional.pad(x, flat)

kernel_name = 'concat_heads__linear_kernel_hedgehog__ssm_conv_s4__prompt'

def setup_inputs():

    _w = (lambda a: (lambda t: t.to(torch.bfloat16) if t.is_floating_point() else t)(torch.as_tensor(a)))
    def _A_setup():
        B, S, D, H = 1, 2048, 448, 16
        Dh = D // H
        return {
            "x": _w((lambda *s: torch.randn(*s, dtype=torch.bfloat16) * 0.4)(B, S, D)),
            "wqkv": _w((lambda *s: torch.randn(*s, dtype=torch.bfloat16) * 0.4)(D, 3 * D)),
            "w_phi": _w((lambda *s: torch.randn(*s, dtype=torch.bfloat16) * 0.4)(H, Dh, Dh) * (Dh ** -0.5)),
            "wo": _w((lambda *s: torch.randn(*s, dtype=torch.bfloat16) * 0.05)(D, D)),
        }
    _A_in = _A_setup()

    def _B_setup():
        B, L, D, N = 1, 2048, 448, 256
        A_re = -(lambda _x: torch.exp(torch.as_tensor(_x)))((lambda *s: torch.randn(*s, dtype=torch.bfloat16) * 3.2)(D, N))
        A_im = torch.pi * (lambda *s: torch.randn(*s, dtype=torch.bfloat16) * 0.2)(D, N)
        B_re = (lambda *s: torch.randn(*s, dtype=torch.bfloat16) * 0.4)(D, N)
        B_im = (lambda *s: torch.randn(*s, dtype=torch.bfloat16) * 0.4)(D, N)
        C_re = (lambda *s: torch.randn(*s, dtype=torch.bfloat16) * 0.4)(D, N)
        C_im = (lambda *s: torch.randn(*s, dtype=torch.bfloat16) * 0.4)(D, N)
        log_dt = (lambda *s: torch.randn(*s, dtype=torch.bfloat16) * 0.2)(D) * 0.5 - 4.0
        Dskip = (lambda *s: torch.randn(*s, dtype=torch.bfloat16) * 0.4)(D)
        return {
            "u": _w((lambda *s: torch.randn(*s, dtype=torch.bfloat16) * 0.05)(B, L, D)),
            "A_re": _w(A_re),
            "A_im": _w(A_im),
            "B_re": _w(B_re),
            "B_im": _w(B_im),
            "C_re": _w(C_re),
            "C_im": _w(C_im),
            "log_dt": _w(log_dt),
            "Dskip": _w(Dskip),
        }
    _B_in = _B_setup()

    return {
        "A_x": _A_in["x"],
        "A_wqkv": _A_in["wqkv"],
        "A_w_phi": _A_in["w_phi"],
        "A_wo": _A_in["wo"],
        "B_u": _B_in["u"],
        "B_A_re": _B_in["A_re"],
        "B_A_im": _B_in["A_im"],
        "B_B_re": _B_in["B_re"],
        "B_B_im": _B_in["B_im"],
        "B_C_re": _B_in["C_re"],
        "B_C_im": _B_in["C_im"],
        "B_log_dt": _B_in["log_dt"],
        "B_Dskip": _B_in["Dskip"],
    }

def reference(A_x, A_wqkv, A_w_phi, A_wo, B_u, B_A_re, B_A_im, B_B_re, B_B_im, B_C_re, B_C_im, B_log_dt, B_Dskip):
    def _A_ref(x, wqkv, w_phi, wo):
        B, S, D = x.shape
        H = 16; Dh = D // H
        qkv = (lambda x, *d: x.permute(*d))((x @ wqkv).reshape(B, S, 3, H, Dh), 2, 0, 3, 1, 4)
        q, k, v = qkv[0], qkv[1], qkv[2]
        pq = torch.einsum("bhsd,hdf->bhsf", q, w_phi)
        pk = torch.einsum("bhsd,hdf->bhsf", k, w_phi)
        phi_q = torch.concatenate([_softmax(pq, axis=-1), _softmax(-pq, axis=-1)], axis=-1)
        phi_k = torch.concatenate([_softmax(pk, axis=-1), _softmax(-pk, axis=-1)], axis=-1)
        kv = torch.einsum("bhsf,bhsd->bhfd", phi_k, v)
        z  = torch.einsum("bhsf->bhf", phi_k)
        num = torch.einsum("bhqf,bhfd->bhqd", phi_q, kv)
        den = torch.einsum("bhqf,bhf->bhq", phi_q, z)[..., None] + 1e-6
        o = num / den
        return (lambda x, *d: x.permute(*d))(o, 0, 2, 1, 3).reshape(B, S, D) @ wo

    def _B_ref(u, A_re, A_im, B_re, B_im, C_re, C_im, log_dt, Dskip):
        Bsz, L, D = u.shape
        dt = torch.exp(log_dt)[:, None]
        A = A_re + 1j * A_im
        Bc = B_re + 1j * B_im
        Cc = C_re + 1j * C_im
        logdA = dt * A
        dB = dt * Bc
        l = (lambda x, dt: x.to(dt))(torch.arange(L), A_re.dtype)
        P = torch.exp(logdA[:, :, None] * l[None, None, :])
        K = torch.einsum("dn,dnl,dn->dl", Cc, P, dB).real
        L2 = 2 * L
        Kp = _pad(K, ((0, 0), (0, L)))
        up = (lambda x, *d: x.permute(*d))(u, 0, 2, 1)
        up = _pad(up, ((0, 0), (0, 0), (0, L)))
        Kf = (lambda x, axes=(-2,-1): torch.fft.rfft2(x.float(), dim=axes))(Kp[:, None, :], axes=(-2, -1))
        Uf = (lambda x, axes=(-2,-1): torch.fft.rfft2(x.float(), dim=axes))(up[:, :, None, :], axes=(-2, -1))
        Yf = Uf * Kf[None, :, :, :]
        y = (lambda x, s, axes=(-2,-1): torch.fft.irfft2(x, s=s, dim=axes).to(torch.bfloat16))(Yf, (1, L2), axes=(-2, -1))[:, :, 0, :L]
        y = (lambda x, *d: x.permute(*d))(y, 0, 2, 1) + u * Dskip[None, None, :]
        return y

    a = _A_ref(A_x, A_wqkv, A_w_phi, A_wo)
    b = _B_ref(B_u, B_A_re, B_A_im, B_B_re, B_B_im, B_C_re, B_C_im, B_log_dt, B_Dskip)
    return torch.concatenate([a, b], axis=-1)
```

```asm
; @launch kernel=l1_kernel grid=(256,1,1) block=(512,1,1) lds=163840
; @launch kernel=l2_kernel grid=(256,1,1) block=(256,1,1) lds=101376
.amdgcn_target "amdgcn-amd-amdhsa--gfx950"
.text
.globl l1_kernel
.p2align 8
.type l1_kernel,@function
l1_kernel:
    s_load_dwordx16 s[4:19], s[0:1], 0
    s_load_dwordx16 s[20:35], s[0:1], 64
    s_cmp_ge_u32 s2, 256
    s_cbranch_scc1 L1_END
    s_cmp_ge_u32 s2, 240
    s_cbranch_scc1 L1_W
    s_cmp_ge_u32 s2, 128
    s_cbranch_scc1 L1_B
    s_and_b32 s42, s2, 3
    s_lshl_b32 s42, s42, 2
    s_bfe_u32 s43, s2, 0x20003
    s_add_u32 s36, s42, s43
    s_bfe_u32 s42, s2, 0x10002
    s_lshl_b32 s42, s42, 2
    s_bfe_u32 s52, s2, 0x20005
    s_add_u32 s37, s42, s52
    s_add_u32 s65, s43, s52
    s_lshl_b32 s65, s65, 1
    s_cmp_ge_u32 s65, 7
    s_cselect_b32 s42, 7, 0
    s_sub_u32 s65, s65, s42
    v_lshrrev_b32 v16, 6, v0
    v_and_b32 v1, 63, v0
    s_nop 0
    v_readfirstlane_b32 s38, v16
    s_mov_b32 s55, 0
    s_and_b32 s39, s38, 3
    s_lshr_b32 s40, s38, 2
    s_lshl_b32 s41, s37, 1
    s_add_u32 s41, s41, s40
    s_lshl_b32 s53, s38, 11
    s_lshl_b32 s54, s38, 10
    s_add_u32 s54, s54, 16384
    v_lshrrev_b32 v16, 3, v1
    v_and_b32 v17, 7, v1
    v_lshrrev_b32 v18, 4, v1
    s_lshl_b32 s42, s36, 7
    s_lshl_b32 s43, s38, 4
    s_add_u32 s42, s42, s43
    v_add_u32 v19, s42, v16
    v_mul_u32_u24 v19, 896, v19
    v_xor_b32 v20, v17, v18
    v_lshl_add_u32 v2, v20, 4, v19
    v_xor_b32 v20, 4, v20
    v_lshl_add_u32 v3, v20, 4, v19
    v_add_u32 v3, 7168, v3
    s_lshl_b32 s43, s38, 3
    v_add_u32 v19, s43, v16
    v_mul_u32_u24 v19, 2688, v19
    v_and_b32 v20, 1, v18
    v_lshlrev_b32 v20, 2, v20
    v_xor_b32 v20, v20, v17
    v_lshl_add_u32 v4, v20, 4, v19
    s_mul_i32 s42, s37, 112
    v_add_u32 v4, s42, v4
    s_waitcnt lgkmcnt(0)
    s_mov_b32 s44, s4
    s_mov_b32 s45, s5
    s_mov_b32 s46, 1835008
    s_mov_b32 s47, 0x00020000
    s_mov_b32 s48, s6
    s_mov_b32 s49, s7
    s_mov_b32 s50, 1204224
    s_mov_b32 s51, 0x00020000
    s_mov_b32 s56, s8
    s_mov_b32 s57, s9
    s_mov_b32 s58, 25088
    s_mov_b32 s59, 0x00020000
    s_mov_b32 s60, s34
    s_mov_b32 s61, s35
    s_mov_b32 s62, 268435456
    s_mov_b32 s63, 0x00020000
    s_cmp_lg_u32 s38, 0
    s_cbranch_scc1 A1_tk_1
    s_lshl_b32 s42, s37, 2
    v_mov_b32 v21, s42
    v_mov_b32 v22, 1
    s_mov_b64 exec, 1
    global_atomic_add v176, v21, v22, s[32:33] sc0
    s_mov_b64 exec, -1
A1_tk_1:
    s_add_u32 s98, s65, 0
    s_cmp_ge_u32 s98, 7
    s_cselect_b32 s99, 7, 0
    s_sub_u32 s98, s98, s99
    s_mul_i32 s99, s98, 172032
    s_lshl_b32 s98, s98, 7
    s_add_u32 m0, s53, 0
    s_nop 0
    buffer_load_dwordx4 v2, s[44:47], s98 offen lds
    s_add_u32 m0, s53, 1024
    s_nop 0
    buffer_load_dwordx4 v3, s[44:47], s98 offen lds
    s_add_u32 m0, s54, 0
    s_add_u32 s52, s99, 0
    buffer_load_dwordx4 v4, s[48:51], s52 offen lds
    s_add_u32 m0, s54, 8192
    s_add_u32 s52, s99, 896
    buffer_load_dwordx4 v4, s[48:51], s52 offen lds
    s_add_u32 m0, s54, 16384
    s_add_u32 s52, s99, 1792
    buffer_load_dwordx4 v4, s[48:51], s52 offen lds
    v_and_b32 v16, 31, v1
    v_lshrrev_b32 v17, 5, v1
    v_add_u32 v18, -4, v16
    v_cmp_gt_u32 vcc, 28, v16
    s_mul_i32 s42, s41, 1568
    v_mul_u32_u24 v19, 224, v17
    v_cndmask_b32 v18, v18, v16, vcc
    v_lshl_add_u32 v18, v18, 1, v19
    v_add_u32 v250, s42, v18
    v_lshlrev_b32 v20, 20, v17
    v_add_u32 v251, v20, v250
    v_bfe_u32 v18, v16, 1, 3
    v_xor_b32 v18, v18, v17
    s_lshl_b32 s42, s39, 12
    v_lshlrev_b32 v19, 7, v16
    v_add_u32 v19, s42, v19
    v_xor_b32 v20, 0, v18
    v_lshl_add_u32 v5, v20, 4, v19
    v_xor_b32 v20, 2, v18
    v_lshl_add_u32 v6, v20, 4, v19
    v_xor_b32 v20, 4, v18
    v_lshl_add_u32 v7, v20, 4, v19
    v_xor_b32 v20, 6, v18
    v_lshl_add_u32 v8, v20, 4, v19
    v_bfe_u32 v18, v1, 2, 2
    v_and_b32 v19, 3, v1
    v_bfe_u32 v20, v1, 4, 1
    v_lshlrev_b32 v19, 3, v19
    v_lshl_add_u32 v19, v20, 5, v19
    s_mul_i32 s42, s40, 56
    v_add_u32 v19, s42, v19
    v_lshrrev_b32 v20, 1, v18
    v_lshlrev_b32 v20, 6, v20
    v_xor_b32 v19, v19, v20
    v_lshl_add_u32 v19, v18, 7, v19
    v_lshl_add_u32 v9, v17, 10, v19
    v_add_u32 v9, 16384, v9
    v_lshlrev_b32 v18, 2, v17
    v_sub_u32 v18, v16, v18
    v_mov_b32 v21, 0x3f80
    v_mov_b32 v22, 0x3f800000
    v_cmp_eq_u32 vcc, 0, v18
    v_mov_b32 v56, 0
    s_nop 0
    v_cndmask_b32 v56, v56, v21, vcc
    v_cmp_eq_u32 vcc, 1, v18
    s_nop 1
    v_cndmask_b32 v56, v56, v22, vcc
    v_cmp_eq_u32 vcc, 2, v18
    v_mov_b32 v57, 0
    s_nop 0
    v_cndmask_b32 v57, v57, v21, vcc
    v_cmp_eq_u32 vcc, 3, v18
    s_nop 1
    v_cndmask_b32 v57, v57, v22, vcc
    v_cmp_eq_u32 vcc, 8, v18
    v_mov_b32 v58, 0
    s_nop 0
    v_cndmask_b32 v58, v58, v21, vcc
    v_cmp_eq_u32 vcc, 9, v18
    s_nop 1
    v_cndmask_b32 v58, v58, v22, vcc
    v_cmp_eq_u32 vcc, 10, v18
    v_mov_b32 v59, 0
    s_nop 0
    v_cndmask_b32 v59, v59, v21, vcc
    v_cmp_eq_u32 vcc, 11, v18
    s_nop 1
    v_cndmask_b32 v59, v59, v22, vcc
    v_cmp_eq_u32 vcc, 16, v18
    v_mov_b32 v60, 0
    s_nop 0
    v_cndmask_b32 v60, v60, v21, vcc
    v_cmp_eq_u32 vcc, 17, v18
    s_nop 1
    v_cndmask_b32 v60, v60, v22, vcc
    v_cmp_eq_u32 vcc, 18, v18
    v_mov_b32 v61, 0
    s_nop 0
    v_cndmask_b32 v61, v61, v21, vcc
    v_cmp_eq_u32 vcc, 19, v18
    s_nop 1
    v_cndmask_b32 v61, v61, v22, vcc
    v_cmp_eq_u32 vcc, 24, v18
    v_mov_b32 v62, 0
    s_nop 0
    v_cndmask_b32 v62, v62, v21, vcc
    v_cmp_eq_u32 vcc, 25, v18
    s_nop 1
    v_cndmask_b32 v62, v62, v22, vcc
    v_cmp_eq_u32 vcc, 26, v18
    v_mov_b32 v63, 0
    s_nop 0
    v_cndmask_b32 v63, v63, v21, vcc
    v_cmp_eq_u32 vcc, 27, v18
    s_nop 1
    v_cndmask_b32 v63, v63, v22, vcc
    s_mul_i32 s42, s38, 9216
    v_lshl_add_u32 v178, v1, 4, s42
    s_mul_i32 s42, s40, 36864
    s_mul_i32 s43, s39, 2304
    s_add_u32 s42, s42, s43
    v_lshrrev_b32 v18, 2, v1
    v_bfe_u32 v19, v1, 1, 1
    v_and_b32 v20, 1, v1
    v_mul_u32_u24 v19, 1152, v19
    v_lshl_add_u32 v19, v18, 4, v19
    v_lshl_add_u32 v19, v20, 3, v19
    v_add_u32 v179, s42, v19
    s_lshl_b32 s42, s36, 2
    s_add_u32 s42, s42, s39
    s_lshl_b32 s42, s42, 4
    s_add_u32 s42, s42, s41
    s_lshl_b32 s42, s42, 12
    v_lshl_add_u32 v180, v1, 4, s42
    s_mov_b32 s64, 1048576
    s_lshl_b32 s42, s41, 12
    s_lshl_b32 s43, s39, 10
    s_add_u32 s42, s42, s43
    v_lshl_add_u32 v181, v1, 2, s42
    s_barrier
    s_add_u32 s98, s65, 1
    s_cmp_ge_u32 s98, 7
    s_cselect_b32 s99, 7, 0
    s_sub_u32 s98, s98, s99
    s_mul_i32 s99, s98, 172032
    s_lshl_b32 s98, s98, 7
    s_add_u32 m0, s53, 40960
    s_nop 0
    buffer_load_dwordx4 v2, s[44:47], s98 offen lds
    s_add_u32 m0, s53, 41984
    s_nop 0
    buffer_load_dwordx4 v3, s[44:47], s98 offen lds
    s_add_u32 m0, s54, 40960
    s_add_u32 s52, s99, 0
    buffer_load_dwordx4 v4, s[48:51], s52 offen lds
    s_add_u32 m0, s54, 49152
    s_add_u32 s52, s99, 896
    buffer_load_dwordx4 v4, s[48:51], s52 offen lds
    s_add_u32 m0, s54, 57344
    s_add_u32 s52, s99, 1792
    buffer_load_dwordx4 v4, s[48:51], s52 offen lds
    s_waitcnt vmcnt(5)
    s_barrier
    s_cmp_lg_u32 s38, 0
    s_cbranch_scc1 A1_z_2
    v_readfirstlane_b32 s42, v176
    s_cmp_lg_u32 s42, 0
    s_cbranch_scc1 A1_z_2
    s_mov_b32 s55, 1
    s_lshl_b32 s42, s37, 13
    v_lshl_add_u32 v24, v1, 4, s42
    v_mov_b32 v28, 0
    v_mov_b32 v29, 0
    v_mov_b32 v30, 0
    v_mov_b32 v31, 0
    v_add_u32 v25, 4096, v24
    buffer_store_dwordx4 v[28:31], v24, s[60:63], 0 offen offset:0 sc1
    buffer_store_dwordx4 v[28:31], v24, s[60:63], 0 offen offset:1024 sc1
    buffer_store_dwordx4 v[28:31], v24, s[60:63], 0 offen offset:2048 sc1
    buffer_store_dwordx4 v[28:31], v24, s[60:63], 0 offen offset:3072 sc1
    buffer_store_dwordx4 v[28:31], v25, s[60:63], 0 offen offset:0 sc1
    buffer_store_dwordx4 v[28:31], v25, s[60:63], 0 offen offset:1024 sc1
    buffer_store_dwordx4 v[28:31], v25, s[60:63], 0 offen offset:2048 sc1
    buffer_store_dwordx4 v[28:31], v25, s[60:63], 0 offen offset:3072 sc1
A1_z_2:
    v_add_u32 v10, 0, v5
    v_add_u32 v11, 0, v6
    v_add_u32 v12, 0, v7
    v_add_u32 v13, 0, v8
    v_add_u32 v14, 0, v9
    ds_read_b128 v[112:115], v10
    ds_read_b64_tr_b16 v[120:121], v14 offset:8192
    ds_read_b64_tr_b16 v[122:123], v14 offset:8704
    ds_read_b64_tr_b16 v[116:117], v14 offset:0
    ds_read_b64_tr_b16 v[118:119], v14 offset:512
    ds_read_b64_tr_b16 v[124:125], v14 offset:16384
    ds_read_b64_tr_b16 v[126:127], v14 offset:16896
    ds_read_b128 v[128:131], v11
    ds_read_b64_tr_b16 v[136:137], v14 offset:10240
    ds_read_b64_tr_b16 v[138:139], v14 offset:10752
    ds_read_b64_tr_b16 v[132:133], v14 offset:2048
    ds_read_b64_tr_b16 v[134:135], v14 offset:2560
    ds_read_b64_tr_b16 v[140:141], v14 offset:18432
    ds_read_b64_tr_b16 v[142:143], v14 offset:18944
    s_add_u32 s98, s65, 2
    s_cmp_ge_u32 s98, 7
    s_cselect_b32 s99, 7, 0
    s_sub_u32 s98, s98, s99
    s_mul_i32 s99, s98, 172032
    s_lshl_b32 s98, s98, 7
    s_add_u32 m0, s53, 81920
    s_nop 0
    buffer_load_dwordx4 v2, s[44:47], s98 offen lds
    s_waitcnt lgkmcnt(7)
    v_mfma_f32_32x32x16_bf16 v[64:79], v[120:123], v[112:115], 0
    v_mfma_f32_32x32x16_bf16 v[80:95], v[116:119], v[112:115], 0
    v_mfma_f32_32x32x16_bf16 v[96:111], v[112:115], v[124:127], 0
    ds_read_b128 v[144:147], v12
    ds_read_b64_tr_b16 v[152:153], v14 offset:12288
    ds_read_b64_tr_b16 v[154:155], v14 offset:12800
    ds_read_b64_tr_b16 v[148:149], v14 offset:4096
    ds_read_b64_tr_b16 v[150:151], v14 offset:4608
    ds_read_b64_tr_b16 v[156:157], v14 offset:20480
    ds_read_b64_tr_b16 v[158:159], v14 offset:20992
    s_add_u32 m0, s53, 82944
    s_nop 0
    buffer_load_dwordx4 v3, s[44:47], s98 offen lds
    s_waitcnt lgkmcnt(7)
    v_mfma_f32_32x32x16_bf16 v[64:79], v[136:139], v[128:131], v[64:79]
    v_mfma_f32_32x32x16_bf16 v[80:95], v[132:135], v[128:131], v[80:95]
    v_mfma_f32_32x32x16_bf16 v[96:111], v[128:131], v[140:143], v[96:111]
    ds_read_b128 v[160:163], v13
    ds_read_b64_tr_b16 v[168:169], v14 offset:14336
    ds_read_b64_tr_b16 v[170:171], v14 offset:14848
    ds_read_b64_tr_b16 v[164:165], v14 offset:6144
    ds_read_b64_tr_b16 v[166:167], v14 offset:6656
    ds_read_b64_tr_b16 v[172:173], v14 offset:22528
    ds_read_b64_tr_b16 v[174:175], v14 offset:23040
    s_add_u32 m0, s54, 81920
    s_add_u32 s52, s99, 0
    buffer_load_dwordx4 v4, s[48:51], s52 offen lds
    s_add_u32 m0, s54, 90112
    s_add_u32 s52, s99, 896
    buffer_load_dwordx4 v4, s[48:51], s52 offen lds
    s_waitcnt lgkmcnt(7)
    v_mfma_f32_32x32x16_bf16 v[64:79], v[152:155], v[144:147], v[64:79]
    v_mfma_f32_32x32x16_bf16 v[80:95], v[148:151], v[144:147], v[80:95]
    v_mfma_f32_32x32x16_bf16 v[96:111], v[144:147], v[156:159], v[96:111]
    s_add_u32 m0, s54, 98304
    s_add_u32 s52, s99, 1792
    buffer_load_dwordx4 v4, s[48:51], s52 offen lds
    s_waitcnt vmcnt(5)
    s_barrier
    v_add_u32 v10, 40960, v5
    v_add_u32 v11, 40960, v6
    v_add_u32 v12, 40960, v7
    v_add_u32 v13, 40960, v8
    v_add_u32 v14, 40960, v9
    ds_read_b128 v[112:115], v10
    ds_read_b64_tr_b16 v[120:121], v14 offset:8192
    ds_read_b64_tr_b16 v[122:123], v14 offset:8704
    ds_read_b64_tr_b16 v[116:117], v14 offset:0
    ds_read_b64_tr_b16 v[118:119], v14 offset:512
    ds_read_b64_tr_b16 v[124:125], v14 offset:16384
    ds_read_b64_tr_b16 v[126:127], v14 offset:16896
    s_waitcnt lgkmcnt(7)
    v_mfma_f32_32x32x16_bf16 v[64:79], v[168:171], v[160:163], v[64:79]
    v_mfma_f32_32x32x16_bf16 v[80:95], v[164:167], v[160:163], v[80:95]
    v_mfma_f32_32x32x16_bf16 v[96:111], v[160:163], v[172:175], v[96:111]
    ds_read_b128 v[128:131], v11
    ds_read_b64_tr_b16 v[136:137], v14 offset:10240
    ds_read_b64_tr_b16 v[138:139], v14 offset:10752
    ds_read_b64_tr_b16 v[132:133], v14 offset:2048
    ds_read_b64_tr_b16 v[134:135], v14 offset:2560
    ds_read_b64_tr_b16 v[140:141], v14 offset:18432
    ds_read_b64_tr_b16 v[142:143], v14 offset:18944
    s_add_u32 s98, s65, 3
    s_cmp_ge_u32 s98, 7
    s_cselect_b32 s99, 7, 0
    s_sub_u32 s98, s98, s99
    s_mul_i32 s99, s98, 172032
    s_lshl_b32 s98, s98, 7
    s_add_u32 m0, s53, 122880
    s_nop 0
    buffer_load_dwordx4 v2, s[44:47], s98 offen lds
    s_waitcnt lgkmcnt(7)
    v_mfma_f32_32x32x16_bf16 v[64:79], v[120:123], v[112:115], v[64:79]
    v_mfma_f32_32x32x16_bf16 v[80:95], v[116:119], v[112:115], v[80:95]
    v_mfma_f32_32x32x16_bf16 v[96:111], v[112:115], v[124:127], v[96:111]
    ds_read_b128 v[144:147], v12
    ds_read_b64_tr_b16 v[152:153], v14 offset:12288
    ds_read_b64_tr_b16 v[154:155], v14 offset:12800
    ds_read_b64_tr_b16 v[148:149], v14 offset:4096
    ds_read_b64_tr_b16 v[150:151], v14 offset:4608
    ds_read_b64_tr_b16 v[156:157], v14 offset:20480
    ds_read_b64_tr_b16 v[158:159], v14 offset:20992
    s_add_u32 m0, s53, 123904
    s_nop 0
    buffer_load_dwordx4 v3, s[44:47], s98 offen lds
    s_waitcnt lgkmcnt(7)
    v_mfma_f32_32x32x16_bf16 v[64:79], v[136:139], v[128:131], v[64:79]
    v_mfma_f32_32x32x16_bf16 v[80:95], v[132:135], v[128:131], v[80:95]
    v_mfma_f32_32x32x16_bf16 v[96:111], v[128:131], v[140:143], v[96:111]
    ds_read_b128 v[160:163], v13
    ds_read_b64_tr_b16 v[168:169], v14 offset:14336
    ds_read_b64_tr_b16 v[170:171], v14 offset:14848
    ds_read_b64_tr_b16 v[164:165], v14 offset:6144
    ds_read_b64_tr_b16 v[166:167], v14 offset:6656
    ds_read_b64_tr_b16 v[172:173], v14 offset:22528
    ds_read_b64_tr_b16 v[174:175], v14 offset:23040
    s_add_u32 m0, s54, 122880
    s_add_u32 s52, s99, 0
    buffer_load_dwordx4 v4, s[48:51], s52 offen lds
    s_add_u32 m0, s54, 131072
    s_add_u32 s52, s99, 896
    buffer_load_dwordx4 v4, s[48:51], s52 offen lds
    s_waitcnt lgkmcnt(7)
    v_mfma_f32_32x32x16_bf16 v[64:79], v[152:155], v[144:147], v[64:79]
    v_mfma_f32_32x32x16_bf16 v[80:95], v[148:151], v[144:147], v[80:95]
    v_mfma_f32_32x32x16_bf16 v[96:111], v[144:147], v[156:159], v[96:111]
    s_add_u32 m0, s54, 139264
    s_add_u32 s52, s99, 1792
    buffer_load_dwordx4 v4, s[48:51], s52 offen lds
    buffer_load_ushort v32, v250, s[56:59], 0 offen offset:0
    buffer_load_ushort v33, v250, s[56:59], 0 offen offset:56
    buffer_load_ushort v34, v250, s[56:59], 0 offen offset:112
    buffer_load_ushort v35, v250, s[56:59], 0 offen offset:168
    buffer_load_ushort v36, v250, s[56:59], 0 offen offset:448
    buffer_load_ushort v37, v250, s[56:59], 0 offen offset:504
    buffer_load_ushort v38, v250, s[56:59], 0 offen offset:560
    buffer_load_ushort v39, v250, s[56:59], 0 offen offset:616
    buffer_load_ushort v40, v250, s[56:59], 0 offen offset:896
    buffer_load_ushort v41, v250, s[56:59], 0 offen offset:952
    buffer_load_ushort v42, v250, s[56:59], 0 offen offset:1008
    buffer_load_ushort v43, v250, s[56:59], 0 offen offset:1064
    buffer_load_ushort v44, v251, s[56:59], 0 offen offset:1344
    buffer_load_ushort v45, v251, s[56:59], 0 offen offset:1400
    buffer_load_ushort v46, v251, s[56:59], 0 offen offset:1456
    buffer_load_ushort v47, v251, s[56:59], 0 offen offset:1512
    s_waitcnt vmcnt(21)
    s_barrier
    v_add_u32 v10, 81920, v5
    v_add_u32 v11, 81920, v6
    v_add_u32 v12, 81920, v7
    v_add_u32 v13, 81920, v8
    v_add_u32 v14, 81920, v9
    ds_read_b128 v[112:115], v10
    ds_read_b64_tr_b16 v[120:121], v14 offset:8192
    ds_read_b64_tr_b16 v[122:123], v14 offset:8704
    ds_read_b64_tr_b16 v[116:117], v14 offset:0
    ds_read_b64_tr_b16 v[118:119], v14 offset:512
    ds_read_b64_tr_b16 v[124:125], v14 offset:16384
    ds_read_b64_tr_b16 v[126:127], v14 offset:16896
    s_waitcnt lgkmcnt(7)
    v_mfma_f32_32x32x16_bf16 v[64:79], v[168:171], v[160:163], v[64:79]
    v_mfma_f32_32x32x16_bf16 v[80:95], v[164:167], v[160:163], v[80:95]
    v_mfma_f32_32x32x16_bf16 v[96:111], v[160:163], v[172:175], v[96:111]
    ds_read_b128 v[128:131], v11
    ds_read_b64_tr_b16 v[136:137], v14 offset:10240
    ds_read_b64_tr_b16 v[138:139], v14 offset:10752
    ds_read_b64_tr_b16 v[132:133], v14 offset:2048
    ds_read_b64_tr_b16 v[134:135], v14 offset:2560
    ds_read_b64_tr_b16 v[140:141], v14 offset:18432
    ds_read_b64_tr_b16 v[142:143], v14 offset:18944
    s_add_u32 s98, s65, 4
    s_cmp_ge_u32 s98, 7
    s_cselect_b32 s99, 7, 0
    s_sub_u32 s98, s98, s99
    s_mul_i32 s99, s98, 172032
    s_lshl_b32 s98, s98, 7
    s_add_u32 m0, s53, 0
    s_nop 0
    buffer_load_dwordx4 v2, s[44:47], s98 offen lds
    s_waitcnt lgkmcnt(7)
    v_mfma_f32_32x32x16_bf16 v[64:79], v[120:123], v[112:115], v[64:79]
    v_mfma_f32_32x32x16_bf16 v[80:95], v[116:119], v[112:115], v[80:95]
    v_mfma_f32_32x32x16_bf16 v[96:111], v[112:115], v[124:127], v[96:111]
    ds_read_b128 v[144:147], v12
    ds_read_b64_tr_b16 v[152:153], v14 offset:12288
    ds_read_b64_tr_b16 v[154:155], v14 offset:12800
    ds_read_b64_tr_b16 v[148:149], v14 offset:4096
    ds_read_b64_tr_b16 v[150:151], v14 offset:4608
    ds_read_b64_tr_b16 v[156:157], v14 offset:20480
    ds_read_b64_tr_b16 v[158:159], v14 offset:20992
    s_add_u32 m0, s53, 1024
    s_nop 0
    buffer_load_dwordx4 v3, s[44:47], s98 offen lds
    s_waitcnt lgkmcnt(7)
    v_mfma_f32_32x32x16_bf16 v[64:79], v[136:139], v[128:131], v[64:79]
    v_mfma_f32_32x32x16_bf16 v[80:95], v[132:135], v[128:131], v[80:95]
    v_mfma_f32_32x32x16_bf16 v[96:111], v[128:131], v[140:143], v[96:111]
    ds_read_b128 v[160:163], v13
    ds_read_b64_tr_b16 v[168:169], v14 offset:14336
    ds_read_b64_tr_b16 v[170:171], v14 offset:14848
    ds_read_b64_tr_b16 v[164:165], v14 offset:6144
    ds_read_b64_tr_b16 v[166:167], v14 offset:6656
    ds_read_b64_tr_b16 v[172:173], v14 offset:22528
    ds_read_b64_tr_b16 v[174:175], v14 offset:23040
    s_add_u32 m0, s54, 0
    s_add_u32 s52, s99, 0
    buffer_load_dwordx4 v4, s[48:51], s52 offen lds
    s_add_u32 m0, s54, 8192
    s_add_u32 s52, s99, 896
    buffer_load_dwordx4 v4, s[48:51], s52 offen lds
    s_waitcnt lgkmcnt(7)
    v_mfma_f32_32x32x16_bf16 v[64:79], v[152:155], v[144:147], v[64:79]
    v_mfma_f32_32x32x16_bf16 v[80:95], v[148:151], v[144:147], v[80:95]
    v_mfma_f32_32x32x16_bf16 v[96:111], v[144:147], v[156:159], v[96:111]
    s_add_u32 m0, s54, 16384
    s_add_u32 s52, s99, 1792
    buffer_load_dwordx4 v4, s[48:51], s52 offen lds
    s_waitcnt vmcnt(21)
    s_barrier
    v_add_u32 v10, 122880, v5
    v_add_u32 v11, 122880, v6
    v_add_u32 v12, 122880, v7
    v_add_u32 v13, 122880, v8
    v_add_u32 v14, 122880, v9
    ds_read_b128 v[112:115], v10
    ds_read_b64_tr_b16 v[120:121], v14 offset:8192
    ds_read_b64_tr_b16 v[122:123], v14 offset:8704
    ds_read_b64_tr_b16 v[116:117], v14 offset:0
    ds_read_b64_tr_b16 v[118:119], v14 offset:512
    ds_read_b64_tr_b16 v[124:125], v14 offset:16384
    ds_read_b64_tr_b16 v[126:127], v14 offset:16896
    s_waitcnt lgkmcnt(7)
    v_mfma_f32_32x32x16_bf16 v[64:79], v[168:171], v[160:163], v[64:79]
    v_mfma_f32_32x32x16_bf16 v[80:95], v[164:167], v[160:163], v[80:95]
    v_mfma_f32_32x32x16_bf16 v[96:111], v[160:163], v[172:175], v[96:111]
    ds_read_b128 v[128:131], v11
    ds_read_b64_tr_b16 v[136:137], v14 offset:10240
    ds_read_b64_tr_b16 v[138:139], v14 offset:10752
    ds_read_b64_tr_b16 v[132:133], v14 offset:2048
    ds_read_b64_tr_b16 v[134:135], v14 offset:2560
    ds_read_b64_tr_b16 v[140:141], v14 offset:18432
    ds_read_b64_tr_b16 v[142:143], v14 offset:18944
    s_add_u32 s98, s65, 5
    s_cmp_ge_u32 s98, 7
    s_cselect_b32 s99, 7, 0
    s_sub_u32 s98, s98, s99
    s_mul_i32 s99, s98, 172032
    s_lshl_b32 s98, s98, 7
    s_add_u32 m0, s53, 40960
    s_nop 0
    buffer_load_dwordx4 v2, s[44:47], s98 offen lds
    s_waitcnt lgkmcnt(7)
    v_mfma_f32_32x32x16_bf16 v[64:79], v[120:123], v[112:115], v[64:79]
    v_mfma_f32_32x32x16_bf16 v[80:95], v[116:119], v[112:115], v[80:95]
    v_mfma_f32_32x32x16_bf16 v[96:111], v[112:115], v[124:127], v[96:111]
    ds_read_b128 v[144:147], v12
    ds_read_b64_tr_b16 v[152:153], v14 offset:12288
    ds_read_b64_tr_b16 v[154:155], v14 offset:12800
    ds_read_b64_tr_b16 v[148:149], v14 offset:4096
    ds_read_b64_tr_b16 v[150:151], v14 offset:4608
    ds_read_b64_tr_b16 v[156:157], v14 offset:20480
    ds_read_b64_tr_b16 v[158:159], v14 offset:20992
    s_add_u32 m0, s53, 41984
    s_nop 0
    buffer_load_dwordx4 v3, s[44:47], s98 offen lds
    s_waitcnt lgkmcnt(7)
    v_mfma_f32_32x32x16_bf16 v[64:79], v[136:139], v[128:131], v[64:79]
    v_mfma_f32_32x32x16_bf16 v[80:95], v[132:135], v[128:131], v[80:95]
    v_mfma_f32_32x32x16_bf16 v[96:111], v[128:131], v[140:143], v[96:111]
    ds_read_b128 v[160:163], v13
    ds_read_b64_tr_b16 v[168:169], v14 offset:14336
    ds_read_b64_tr_b16 v[170:171], v14 offset:14848
    ds_read_b64_tr_b16 v[164:165], v14 offset:6144
    ds_read_b64_tr_b16 v[166:167], v14 offset:6656
    ds_read_b64_tr_b16 v[172:173], v14 offset:22528
    ds_read_b64_tr_b16 v[174:175], v14 offset:23040
    s_add_u32 m0, s54, 40960
    s_add_u32 s52, s99, 0
    buffer_load_dwordx4 v4, s[48:51], s52 offen lds
    s_add_u32 m0, s54, 49152
    s_add_u32 s52, s99, 896
    buffer_load_dwordx4 v4, s[48:51], s52 offen lds
    s_waitcnt lgkmcnt(7)
    v_mfma_f32_32x32x16_bf16 v[64:79], v[152:155], v[144:147], v[64:79]
    v_mfma_f32_32x32x16_bf16 v[80:95], v[148:151], v[144:147], v[80:95]
    v_mfma_f32_32x32x16_bf16 v[96:111], v[144:147], v[156:159], v[96:111]
    s_add_u32 m0, s54, 57344
    s_add_u32 s52, s99, 1792
    buffer_load_dwordx4 v4, s[48:51], s52 offen lds
    s_waitcnt vmcnt(5)
    s_barrier
    s_cmp_eq_u32 s55, 0
    s_cbranch_scc1 A1_f_3
    s_waitcnt vmcnt(0)
    s_lshl_b32 s42, s37, 2
    v_mov_b32 v24, s42
    v_mov_b32 v25, 1
    s_mov_b64 exec, 1
    global_store_dword v24, v25, s[32:33] offset:64 sc1
    s_mov_b64 exec, -1
A1_f_3:
    v_add_u32 v10, 0, v5
    v_add_u32 v11, 0, v6
    v_add_u32 v12, 0, v7
    v_add_u32 v13, 0, v8
    v_add_u32 v14, 0, v9
    ds_read_b128 v[112:115], v10
    ds_read_b64_tr_b16 v[120:121], v14 offset:8192
    ds_read_b64_tr_b16 v[122:123], v14 offset:8704
    ds_read_b64_tr_b16 v[116:117], v14 offset:0
    ds_read_b64_tr_b16 v[118:119], v14 offset:512
    ds_read_b64_tr_b16 v[124:125], v14 offset:16384
    ds_read_b64_tr_b16 v[126:127], v14 offset:16896
    s_waitcnt lgkmcnt(7)
    v_mfma_f32_32x32x16_bf16 v[64:79], v[168:171], v[160:163], v[64:79]
    v_mfma_f32_32x32x16_bf16 v[80:95], v[164:167], v[160:163], v[80:95]
    v_mfma_f32_32x32x16_bf16 v[96:111], v[160:163], v[172:175], v[96:111]
    ds_read_b128 v[128:131], v11
    ds_read_b64_tr_b16 v[136:137], v14 offset:10240
    ds_read_b64_tr_b16 v[138:139], v14 offset:10752
    ds_read_b64_tr_b16 v[132:133], v14 offset:2048
    ds_read_b64_tr_b16 v[134:135], v14 offset:2560
    ds_read_b64_tr_b16 v[140:141], v14 offset:18432
    ds_read_b64_tr_b16 v[142:143], v14 offset:18944
    s_add_u32 s98, s65, 6
    s_cmp_ge_u32 s98, 7
    s_cselect_b32 s99, 7, 0
    s_sub_u32 s98, s98, s99
    s_mul_i32 s99, s98, 172032
    s_lshl_b32 s98, s98, 7
    s_add_u32 m0, s53, 81920
    s_nop 0
    buffer_load_dwordx4 v2, s[44:47], s98 offen lds
    s_waitcnt lgkmcnt(7)
    v_mfma_f32_32x32x16_bf16 v[64:79], v[120:123], v[112:115], v[64:79]
    v_mfma_f32_32x32x16_bf16 v[80:95], v[116:119], v[112:115], v[80:95]
    v_mfma_f32_32x32x16_bf16 v[96:111], v[112:115], v[124:127], v[96:111]
    ds_read_b128 v[144:147], v12
    ds_read_b64_tr_b16 v[152:153], v14 offset:12288
    ds_read_b64_tr_b16 v[154:155], v14 offset:12800
    ds_read_b64_tr_b16 v[148:149], v14 offset:4096
    ds_read_b64_tr_b16 v[150:151], v14 offset:4608
    ds_read_b64_tr_b16 v[156:157], v14 offset:20480
    ds_read_b64_tr_b16 v[158:159], v14 offset:20992
    s_add_u32 m0, s53, 82944
    s_nop 0
    buffer_load_dwordx4 v3, s[44:47], s98 offen lds
    s_waitcnt lgkmcnt(7)
    v_mfma_f32_32x32x16_bf16 v[64:79], v[136:139], v[128:131], v[64:79]
    v_mfma_f32_32x32x16_bf16 v[80:95], v[132:135], v[128:131], v[80:95]
    v_mfma_f32_32x32x16_bf16 v[96:111], v[128:131], v[140:143], v[96:111]
    ds_read_b128 v[160:163], v13
    ds_read_b64_tr_b16 v[168:169], v14 offset:14336
    ds_read_b64_tr_b16 v[170:171], v14 offset:14848
    ds_read_b64_tr_b16 v[164:165], v14 offset:6144
    ds_read_b64_tr_b16 v[166:167], v14 offset:6656
    ds_read_b64_tr_b16 v[172:173], v14 offset:22528
    ds_read_b64_tr_b16 v[174:175], v14 offset:23040
    s_add_u32 m0, s54, 81920
    s_add_u32 s52, s99, 0
    buffer_load_dwordx4 v4, s[48:51], s52 offen lds
    s_add_u32 m0, s54, 90112
    s_add_u32 s52, s99, 896
    buffer_load_dwordx4 v4, s[48:51], s52 offen lds
    s_waitcnt lgkmcnt(7)
    v_mfma_f32_32x32x16_bf16 v[64:79], v[152:155], v[144:147], v[64:79]
    v_mfma_f32_32x32x16_bf16 v[80:95], v[148:151], v[144:147], v[80:95]
    v_mfma_f32_32x32x16_bf16 v[96:111], v[144:147], v[156:159], v[96:111]
    s_add_u32 m0, s54, 98304
    s_add_u32 s52, s99, 1792
    buffer_load_dwordx4 v4, s[48:51], s52 offen lds
    s_waitcnt vmcnt(5)
    s_barrier
    v_add_u32 v10, 40960, v5
    v_add_u32 v11, 40960, v6
    v_add_u32 v12, 40960, v7
    v_add_u32 v13, 40960, v8
    v_add_u32 v14, 40960, v9
    ds_read_b128 v[112:115], v10
    ds_read_b64_tr_b16 v[120:121], v14 offset:8192
    ds_read_b64_tr_b16 v[122:123], v14 offset:8704
    ds_read_b64_tr_b16 v[116:117], v14 offset:0
    ds_read_b64_tr_b16 v[118:119], v14 offset:512
    ds_read_b64_tr_b16 v[124:125], v14 offset:16384
    ds_read_b64_tr_b16 v[126:127], v14 offset:16896
    s_waitcnt lgkmcnt(7)
    v_mfma_f32_32x32x16_bf16 v[64:79], v[168:171], v[160:163], v[64:79]
    v_mfma_f32_32x32x16_bf16 v[80:95], v[164:167], v[160:163], v[80:95]
    v_mfma_f32_32x32x16_bf16 v[96:111], v[160:163], v[172:175], v[96:111]
    ds_read_b128 v[128:131], v11
    ds_read_b64_tr_b16 v[136:137], v14 offset:10240
    ds_read_b64_tr_b16 v[138:139], v14 offset:10752
    ds_read_b64_tr_b16 v[132:133], v14 offset:2048
    ds_read_b64_tr_b16 v[134:135], v14 offset:2560
    ds_read_b64_tr_b16 v[140:141], v14 offset:18432
    ds_read_b64_tr_b16 v[142:143], v14 offset:18944
    s_waitcnt lgkmcnt(7)
    v_mfma_f32_32x32x16_bf16 v[64:79], v[120:123], v[112:115], v[64:79]
    v_mfma_f32_32x32x16_bf16 v[80:95], v[116:119], v[112:115], v[80:95]
    v_mfma_f32_32x32x16_bf16 v[96:111], v[112:115], v[124:127], v[96:111]
    ds_read_b128 v[144:147], v12
    ds_read_b64_tr_b16 v[152:153], v14 offset:12288
    ds_read_b64_tr_b16 v[154:155], v14 offset:12800
    ds_read_b64_tr_b16 v[148:149], v14 offset:4096
    ds_read_b64_tr_b16 v[150:151], v14 offset:4608
    ds_read_b64_tr_b16 v[156:157], v14 offset:20480
    ds_read_b64_tr_b16 v[158:159], v14 offset:20992
    s_waitcnt lgkmcnt(7)
    v_mfma_f32_32x32x16_bf16 v[64:79], v[136:139], v[128:131], v[64:79]
    v_mfma_f32_32x32x16_bf16 v[80:95], v[132:135], v[128:131], v[80:95]
    v_mfma_f32_32x32x16_bf16 v[96:111], v[128:131], v[140:143], v[96:111]
    ds_read_b128 v[160:163], v13
    ds_read_b64_tr_b16 v[168:169], v14 offset:14336
    ds_read_b64_tr_b16 v[170:171], v14 offset:14848
    ds_read_b64_tr_b16 v[164:165], v14 offset:6144
    ds_read_b64_tr_b16 v[166:167], v14 offset:6656
    ds_read_b64_tr_b16 v[172:173], v14 offset:22528
    ds_read_b64_tr_b16 v[174:175], v14 offset:23040
    s_waitcnt lgkmcnt(7)
    v_mfma_f32_32x32x16_bf16 v[64:79], v[152:155], v[144:147], v[64:79]
    v_mfma_f32_32x32x16_bf16 v[80:95], v[148:151], v[144:147], v[80:95]
    v_mfma_f32_32x32x16_bf16 v[96:111], v[144:147], v[156:159], v[96:111]
    v_lshl_or_b32 v48, v33, 16, v32
    v_lshl_or_b32 v49, v35, 16, v34
    v_lshl_or_b32 v50, v37, 16, v36
    v_lshl_or_b32 v51, v39, 16, v38
    v_lshl_or_b32 v52, v41, 16, v40
    v_lshl_or_b32 v53, v43, 16, v42
    v_lshl_or_b32 v54, v45, 16, v44
    v_lshl_or_b32 v55, v47, 16, v46
    s_waitcnt vmcnt(0)
    s_barrier
    v_add_u32 v10, 81920, v5
    v_add_u32 v11, 81920, v6
    v_add_u32 v12, 81920, v7
    v_add_u32 v13, 81920, v8
    v_add_u32 v14, 81920, v9
    ds_read_b128 v[112:115], v10
    ds_read_b64_tr_b16 v[120:121], v14 offset:8192
    ds_read_b64_tr_b16 v[122:123], v14 offset:8704
    ds_read_b64_tr_b16 v[116:117], v14 offset:0
    ds_read_b64_tr_b16 v[118:119], v14 offset:512
    ds_read_b64_tr_b16 v[124:125], v14 offset:16384
    ds_read_b64_tr_b16 v[126:127], v14 offset:16896
    s_waitcnt lgkmcnt(7)
    v_mfma_f32_32x32x16_bf16 v[64:79], v[168:171], v[160:163], v[64:79]
    v_mfma_f32_32x32x16_bf16 v[80:95], v[164:167], v[160:163], v[80:95]
    v_mfma_f32_32x32x16_bf16 v[96:111], v[160:163], v[172:175], v[96:111]
    ds_read_b128 v[128:131], v11
    ds_read_b64_tr_b16 v[136:137], v14 offset:10240
    ds_read_b64_tr_b16 v[138:139], v14 offset:10752
    ds_read_b64_tr_b16 v[132:133], v14 offset:2048
    ds_read_b64_tr_b16 v[134:135], v14 offset:2560
    ds_read_b64_tr_b16 v[140:141], v14 offset:18432
    ds_read_b64_tr_b16 v[142:143], v14 offset:18944
    s_waitcnt lgkmcnt(7)
    v_mfma_f32_32x32x16_bf16 v[64:79], v[120:123], v[112:115], v[64:79]
    v_mfma_f32_32x32x16_bf16 v[80:95], v[116:119], v[112:115], v[80:95]
    v_mfma_f32_32x32x16_bf16 v[96:111], v[112:115], v[124:127], v[96:111]
    ds_read_b128 v[144:147], v12
    ds_read_b64_tr_b16 v[152:153], v14 offset:12288
    ds_read_b64_tr_b16 v[154:155], v14 offset:12800
    ds_read_b64_tr_b16 v[148:149], v14 offset:4096
    ds_read_b64_tr_b16 v[150:151], v14 offset:4608
    ds_read_b64_tr_b16 v[156:157], v14 offset:20480
    ds_read_b64_tr_b16 v[158:159], v14 offset:20992
    s_waitcnt lgkmcnt(7)
    v_mfma_f32_32x32x16_bf16 v[64:79], v[136:139], v[128:131], v[64:79]
    v_mfma_f32_32x32x16_bf16 v[80:95], v[132:135], v[128:131], v[80:95]
    v_mfma_f32_32x32x16_bf16 v[96:111], v[128:131], v[140:143], v[96:111]
    ds_read_b128 v[160:163], v13
    ds_read_b64_tr_b16 v[168:169], v14 offset:14336
    ds_read_b64_tr_b16 v[170:171], v14 offset:14848
    ds_read_b64_tr_b16 v[164:165], v14 offset:6144
    ds_read_b64_tr_b16 v[166:167], v14 offset:6656
    ds_read_b64_tr_b16 v[172:173], v14 offset:22528
    ds_read_b64_tr_b16 v[174:175], v14 offset:23040
    s_waitcnt lgkmcnt(7)
    v_mfma_f32_32x32x16_bf16 v[64:79], v[152:155], v[144:147], v[64:79]
    v_mfma_f32_32x32x16_bf16 v[80:95], v[148:151], v[144:147], v[80:95]
    v_mfma_f32_32x32x16_bf16 v[96:111], v[144:147], v[156:159], v[96:111]
    s_waitcnt lgkmcnt(0)
    v_mfma_f32_32x32x16_bf16 v[64:79], v[168:171], v[160:163], v[64:79]
    v_mfma_f32_32x32x16_bf16 v[80:95], v[164:167], v[160:163], v[80:95]
    v_mfma_f32_32x32x16_bf16 v[96:111], v[160:163], v[172:175], v[96:111]
    s_lshl_b32 s42, s37, 2
    v_mov_b32 v182, s42
    s_cmp_lg_u32 s38, 0
    s_cbranch_scc1 A1_p_4
    global_load_dword v177, v182, s[32:33] offset:64 sc1
A1_p_4:
    s_nop 7
    s_nop 7
    v_cvt_pk_bf16_f32 v112, v64, v65
    v_cvt_pk_bf16_f32 v113, v66, v67
    v_cvt_pk_bf16_f32 v114, v68, v69
    v_cvt_pk_bf16_f32 v115, v70, v71
    v_cvt_pk_bf16_f32 v116, v72, v73
    v_cvt_pk_bf16_f32 v117, v74, v75
    v_cvt_pk_bf16_f32 v118, v76, v77
    v_cvt_pk_bf16_f32 v119, v78, v79
    s_nop 1
    v_mfma_f32_32x32x16_bf16 v[136:151], v[48:51], v[112:115], 0
    v_cvt_pk_bf16_f32 v120, v80, v81
    v_cvt_pk_bf16_f32 v121, v82, v83
    v_cvt_pk_bf16_f32 v122, v84, v85
    v_cvt_pk_bf16_f32 v123, v86, v87
    v_cvt_pk_bf16_f32 v124, v88, v89
    v_cvt_pk_bf16_f32 v125, v90, v91
    v_cvt_pk_bf16_f32 v126, v92, v93
    v_cvt_pk_bf16_f32 v127, v94, v95
    v_mfma_f32_32x32x16_bf16 v[136:151], v[52:55], v[116:119], v[136:151]
    v_and_b32 v16, 31, v1
    v_cmp_eq_u32 vcc, 28, v16
    v_mov_b32 v17, 0x3f803f80
    v_cvt_pk_bf16_f32 v128, v96, v97
    v_cvt_pk_bf16_f32 v129, v98, v99
    v_cvt_pk_bf16_f32 v130, v100, v101
    v_cvt_pk_bf16_f32 v131, v102, v103
    v_cvt_pk_bf16_f32 v132, v104, v105
    v_cvt_pk_bf16_f32 v133, v106, v107
    v_cvt_pk_bf16_f32 v134, v108, v109
    v_cvt_pk_bf16_f32 v135, v110, v111
    v_cndmask_b32 v128, v128, v17, vcc
    v_cndmask_b32 v129, v129, v17, vcc
    v_cndmask_b32 v130, v130, v17, vcc
    v_cndmask_b32 v131, v131, v17, vcc
    v_cndmask_b32 v132, v132, v17, vcc
    v_cndmask_b32 v133, v133, v17, vcc
    v_cndmask_b32 v134, v134, v17, vcc
    v_cndmask_b32 v135, v135, v17, vcc
    v_mov_b32 v24, 0x3fb8aa3b
    v_mov_b32 v25, 0xbfb8aa3b
    v_cmp_gt_u32 vcc, 32, v1
    v_mov_b32 v26, 0
    s_nop 0
    v_cndmask_b32 v26, v26, 1.0, vcc
    s_nop 7
    v_max3_f32 v16, v136, v137, v138
    v_min3_f32 v18, v136, v137, v138
    v_max3_f32 v17, v139, v140, v141
    v_min3_f32 v19, v139, v140, v141
    v_max3_f32 v16, v16, v142, v143
    v_min3_f32 v18, v18, v142, v143
    v_max3_f32 v17, v17, v144, v145
    v_min3_f32 v19, v19, v144, v145
    v_max3_f32 v16, v16, v146, v147
    v_min3_f32 v18, v18, v146, v147
    v_max3_f32 v17, v17, v148, v149
    v_min3_f32 v19, v19, v148, v149
    v_max3_f32 v16, v16, v150, v151
    v_min3_f32 v18, v18, v150, v151
    v_max_f32 v16, v16, v17
    v_min_f32 v18, v18, v19
    v_mov_b32 v17, v16
    v_mov_b32 v19, v18
    s_nop 1
    v_permlane32_swap_b32 v16, v17
    v_permlane32_swap_b32 v18, v19
    s_nop 0
    v_max_f32 v16, v16, v17
    v_min_f32 v18, v18, v19
    v_mul_f32 v20, v25, v16
    v_mul_f32 v21, v24, v18
    v_pk_fma_f32 v[64:65], v[136:137], v[24:25], v[20:21] op_sel:[0,0,0] op_sel_hi:[1,0,0]
    v_pk_fma_f32 v[80:81], v[136:137], v[24:25], v[20:21] op_sel:[0,1,1] op_sel_hi:[1,1,1]
    v_pk_fma_f32 v[66:67], v[138:139], v[24:25], v[20:21] op_sel:[0,0,0] op_sel_hi:[1,0,0]
    v_pk_fma_f32 v[82:83], v[138:139], v[24:25], v[20:21] op_sel:[0,1,1] op_sel_hi:[1,1,1]
    v_pk_fma_f32 v[68:69], v[140:141], v[24:25], v[20:21] op_sel:[0,0,0] op_sel_hi:[1,0,0]
    v_pk_fma_f32 v[84:85], v[140:141], v[24:25], v[20:21] op_sel:[0,1,1] op_sel_hi:[1,1,1]
    v_pk_fma_f32 v[70:71], v[142:143], v[24:25], v[20:21] op_sel:[0,0,0] op_sel_hi:[1,0,0]
    v_pk_fma_f32 v[86:87], v[142:143], v[24:25], v[20:21] op_sel:[0,1,1] op_sel_hi:[1,1,1]
    v_pk_fma_f32 v[72:73], v[144:145], v[24:25], v[20:21] op_sel:[0,0,0] op_sel_hi:[1,0,0]
    v_pk_fma_f32 v[88:89], v[144:145], v[24:25], v[20:21] op_sel:[0,1,1] op_sel_hi:[1,1,1]
    v_pk_fma_f32 v[74:75], v[146:147], v[24:25], v[20:21] op_sel:[0,0,0] op_sel_hi:[1,0,0]
    v_pk_fma_f32 v[90:91], v[146:147], v[24:25], v[20:21] op_sel:[0,1,1] op_sel_hi:[1,1,1]
    v_pk_fma_f32 v[76:77], v[148:149], v[24:25], v[20:21] op_sel:[0,0,0] op_sel_hi:[1,0,0]
    v_pk_fma_f32 v[92:93], v[148:149], v[24:25], v[20:21] op_sel:[0,1,1] op_sel_hi:[1,1,1]
    v_pk_fma_f32 v[78:79], v[150:151], v[24:25], v[20:21] op_sel:[0,0,0] op_sel_hi:[1,0,0]
    v_pk_fma_f32 v[94:95], v[150:151], v[24:25], v[20:21] op_sel:[0,1,1] op_sel_hi:[1,1,1]
    v_mfma_f32_32x32x16_bf16 v[152:167], v[48:51], v[120:123], 0
    v_exp_f32 v64, v64
    v_exp_f32 v80, v80
    v_exp_f32 v65, v65
    v_exp_f32 v81, v81
    v_mfma_f32_32x32x16_bf16 v[152:167], v[52:55], v[124:127], v[152:167]
    v_exp_f32 v66, v66
    v_exp_f32 v82, v82
    v_exp_f32 v67, v67
    v_exp_f32 v83, v83
    v_exp_f32 v68, v68
    v_exp_f32 v84, v84
    v_exp_f32 v69, v69
    v_exp_f32 v85, v85
    v_exp_f32 v70, v70
    v_exp_f32 v86, v86
    v_exp_f32 v71, v71
    v_exp_f32 v87, v87
    v_exp_f32 v72, v72
    v_exp_f32 v88, v88
    v_exp_f32 v73, v73
    v_exp_f32 v89, v89
    v_exp_f32 v74, v74
    v_exp_f32 v90, v90
    v_exp_f32 v75, v75
    v_exp_f32 v91, v91
    v_exp_f32 v76, v76
    v_exp_f32 v92, v92
    v_exp_f32 v77, v77
    v_exp_f32 v93, v93
    v_exp_f32 v78, v78
    v_exp_f32 v94, v94
    v_exp_f32 v79, v79
    v_exp_f32 v95, v95
    v_pk_add_f32 v[16:17], v[64:65], v[66:67]
    v_pk_add_f32 v[18:19], v[80:81], v[82:83]
    v_pk_add_f32 v[20:21], v[76:77], v[78:79]
    v_pk_add_f32 v[22:23], v[92:93], v[94:95]
    v_pk_add_f32 v[16:17], v[16:17], v[68:69]
    v_pk_add_f32 v[18:19], v[18:19], v[84:85]
    v_pk_add_f32 v[16:17], v[16:17], v[70:71]
    v_pk_add_f32 v[18:19], v[18:19], v[86:87]
    v_pk_add_f32 v[16:17], v[16:17], v[72:73]
    v_pk_add_f32 v[18:19], v[18:19], v[88:89]
    v_pk_add_f32 v[16:17], v[16:17], v[74:75]
    v_pk_add_f32 v[18:19], v[18:19], v[90:91]
    v_pk_fma_f32 v[16:17], v[20:21], v[26:27], v[16:17] op_sel:[0,0,0] op_sel_hi:[1,0,1]
    v_pk_fma_f32 v[18:19], v[22:23], v[26:27], v[18:19] op_sel:[0,0,0] op_sel_hi:[1,0,1]
    v_add_f32 v16, v16, v17
    v_add_f32 v18, v18, v19
    v_mov_b32 v17, v16
    v_mov_b32 v19, v18
    s_nop 1
    v_permlane32_swap_b32 v16, v17
    v_permlane32_swap_b32 v18, v19
    s_nop 0
    v_add_f32 v16, v16, v17
    v_add_f32 v18, v18, v19
    v_rcp_f32 v16, v16
    v_rcp_f32 v18, v18
    s_nop 0
    v_mul_f32 v17, v26, v16
    v_mul_f32 v19, v26, v18
    v_pk_mul_f32 v[64:65], v[64:65], v[16:17] op_sel:[0,0] op_sel_hi:[1,0]
    v_pk_mul_f32 v[80:81], v[80:81], v[18:19] op_sel:[0,0] op_sel_hi:[1,0]
    v_pk_mul_f32 v[66:67], v[66:67], v[16:17] op_sel:[0,0] op_sel_hi:[1,0]
    v_pk_mul_f32 v[82:83], v[82:83], v[18:19] op_sel:[0,0] op_sel_hi:[1,0]
    v_pk_mul_f32 v[68:69], v[68:69], v[16:17] op_sel:[0,0] op_sel_hi:[1,0]
    v_pk_mul_f32 v[84:85], v[84:85], v[18:19] op_sel:[0,0] op_sel_hi:[1,0]
    v_pk_mul_f32 v[70:71], v[70:71], v[16:17] op_sel:[0,0] op_sel_hi:[1,0]
    v_pk_mul_f32 v[86:87], v[86:87], v[18:19] op_sel:[0,0] op_sel_hi:[1,0]
    v_pk_mul_f32 v[72:73], v[72:73], v[16:17] op_sel:[0,0] op_sel_hi:[1,0]
    v_pk_mul_f32 v[88:89], v[88:89], v[18:19] op_sel:[0,0] op_sel_hi:[1,0]
    v_pk_mul_f32 v[74:75], v[74:75], v[16:17] op_sel:[0,0] op_sel_hi:[1,0]
    v_pk_mul_f32 v[90:91], v[90:91], v[18:19] op_sel:[0,0] op_sel_hi:[1,0]
    v_pk_mul_f32 v[76:77], v[76:77], v[16:17] op_sel:[0,1] op_sel_hi:[1,1]
    v_pk_mul_f32 v[92:93], v[92:93], v[18:19] op_sel:[0,1] op_sel_hi:[1,1]
    v_pk_mul_f32 v[78:79], v[78:79], v[16:17] op_sel:[0,1] op_sel_hi:[1,1]
    v_pk_mul_f32 v[94:95], v[94:95], v[18:19] op_sel:[0,1] op_sel_hi:[1,1]
    v_cvt_pk_bf16_f32 v184, v64, v65
    v_cvt_pk_bf16_f32 v185, v66, v67
    v_cvt_pk_bf16_f32 v186, v68, v69
    v_cvt_pk_bf16_f32 v187, v70, v71
    v_cvt_pk_bf16_f32 v188, v72, v73
    v_cvt_pk_bf16_f32 v189, v74, v75
    v_cvt_pk_bf16_f32 v190, v76, v77
    v_cvt_pk_bf16_f32 v191, v78, v79
    v_cvt_pk_bf16_f32 v192, v80, v81
    v_cvt_pk_bf16_f32 v193, v82, v83
    v_cvt_pk_bf16_f32 v194, v84, v85
    v_cvt_pk_bf16_f32 v195, v86, v87
    v_cvt_pk_bf16_f32 v196, v88, v89
    v_cvt_pk_bf16_f32 v197, v90, v91
    v_cvt_pk_bf16_f32 v198, v92, v93
    v_cvt_pk_bf16_f32 v199, v94, v95
    s_nop 1
    v_mfma_f32_32x32x16_bf16 v[64:79], v[184:187], v[56:59], 0
    v_max3_f32 v16, v152, v153, v154
    v_min3_f32 v18, v152, v153, v154
    v_max3_f32 v17, v155, v156, v157
    v_min3_f32 v19, v155, v156, v157
    v_max3_f32 v16, v16, v158, v159
    v_mfma_f32_32x32x16_bf16 v[80:95], v[192:195], v[56:59], 0
    v_min3_f32 v18, v18, v158, v159
    v_max3_f32 v17, v17, v160, v161
    v_min3_f32 v19, v19, v160, v161
    v_max3_f32 v16, v16, v162, v163
    v_min3_f32 v18, v18, v162, v163
    v_mfma_f32_32x32x16_bf16 v[64:79], v[188:191], v[60:63], v[64:79]
    v_max3_f32 v17, v17, v164, v165
    v_min3_f32 v19, v19, v164, v165
    v_max3_f32 v16, v16, v166, v167
    v_min3_f32 v18, v18, v166, v167
    v_max_f32 v16, v16, v17
    v_mfma_f32_32x32x16_bf16 v[80:95], v[196:199], v[60:63], v[80:95]
    v_min_f32 v18, v18, v19
    v_mov_b32 v17, v16
    v_mov_b32 v19, v18
    s_nop 1
    v_permlane32_swap_b32 v16, v17
    v_permlane32_swap_b32 v18, v19
    s_nop 0
    v_max_f32 v16, v16, v17
    v_min_f32 v18, v18, v19
    v_mul_f32 v20, v25, v16
    v_mul_f32 v21, v24, v18
    v_pk_fma_f32 v[216:217], v[152:153], v[24:25], v[20:21] op_sel:[0,0,0] op_sel_hi:[1,0,0]
    v_pk_fma_f32 v[232:233], v[152:153], v[24:25], v[20:21] op_sel:[0,1,1] op_sel_hi:[1,1,1]
    v_pk_fma_f32 v[218:219], v[154:155], v[24:25], v[20:21] op_sel:[0,0,0] op_sel_hi:[1,0,0]
    v_pk_fma_f32 v[234:235], v[154:155], v[24:25], v[20:21] op_sel:[0,1,1] op_sel_hi:[1,1,1]
    v_pk_fma_f32 v[220:221], v[156:157], v[24:25], v[20:21] op_sel:[0,0,0] op_sel_hi:[1,0,0]
    v_pk_fma_f32 v[236:237], v[156:157], v[24:25], v[20:21] op_sel:[0,1,1] op_sel_hi:[1,1,1]
    v_pk_fma_f32 v[222:223], v[158:159], v[24:25], v[20:21] op_sel:[0,0,0] op_sel_hi:[1,0,0]
    v_pk_fma_f32 v[238:239], v[158:159], v[24:25], v[20:21] op_sel:[0,1,1] op_sel_hi:[1,1,1]
    v_pk_fma_f32 v[224:225], v[160:161], v[24:25], v[20:21] op_sel:[0,0,0] op_sel_hi:[1,0,0]
    v_pk_fma_f32 v[240:241], v[160:161], v[24:25], v[20:21] op_sel:[0,1,1] op_sel_hi:[1,1,1]
    v_pk_fma_f32 v[226:227], v[162:163], v[24:25], v[20:21] op_sel:[0,0,0] op_sel_hi:[1,0,0]
    v_pk_fma_f32 v[242:243], v[162:163], v[24:25], v[20:21] op_sel:[0,1,1] op_sel_hi:[1,1,1]
    v_pk_fma_f32 v[228:229], v[164:165], v[24:25], v[20:21] op_sel:[0,0,0] op_sel_hi:[1,0,0]
    v_pk_fma_f32 v[244:245], v[164:165], v[24:25], v[20:21] op_sel:[0,1,1] op_sel_hi:[1,1,1]
    v_pk_fma_f32 v[230:231], v[166:167], v[24:25], v[20:21] op_sel:[0,0,0] op_sel_hi:[1,0,0]
    v_pk_fma_f32 v[246:247], v[166:167], v[24:25], v[20:21] op_sel:[0,1,1] op_sel_hi:[1,1,1]
    v_cvt_pk_bf16_f32 v136, v64, v65
    v_cvt_pk_bf16_f32 v137, v66, v67
    v_cvt_pk_bf16_f32 v138, v68, v69
    v_cvt_pk_bf16_f32 v139, v70, v71
    v_cvt_pk_bf16_f32 v140, v72, v73
    v_cvt_pk_bf16_f32 v141, v74, v75
    v_cvt_pk_bf16_f32 v142, v76, v77
    v_cvt_pk_bf16_f32 v143, v78, v79
    v_cvt_pk_bf16_f32 v144, v80, v81
    v_cvt_pk_bf16_f32 v145, v82, v83
    v_cvt_pk_bf16_f32 v146, v84, v85
    v_cvt_pk_bf16_f32 v147, v86, v87
    v_cvt_pk_bf16_f32 v148, v88, v89
    v_cvt_pk_bf16_f32 v149, v90, v91
    v_cvt_pk_bf16_f32 v150, v92, v93
    v_cvt_pk_bf16_f32 v151, v94, v95
    v_mfma_f32_32x32x16_bf16 v[96:111], v[136:139], v[128:131], 0
    v_exp_f32 v216, v216
    v_exp_f32 v232, v232
    v_exp_f32 v217, v217
    v_exp_f32 v233, v233
    v_mfma_f32_32x32x16_bf16 v[112:127], v[144:147], v[128:131], 0
    v_exp_f32 v218, v218
    v_exp_f32 v234, v234
    v_exp_f32 v219, v219
    v_exp_f32 v235, v235
    v_mfma_f32_32x32x16_bf16 v[96:111], v[140:143], v[132:135], v[96:111]
    v_exp_f32 v220, v220
    v_exp_f32 v236, v236
    v_exp_f32 v221, v221
    v_exp_f32 v237, v237
    v_mfma_f32_32x32x16_bf16 v[112:127], v[148:151], v[132:135], v[112:127]
    v_exp_f32 v222, v222
    v_exp_f32 v238, v238
    v_exp_f32 v223, v223
    v_exp_f32 v239, v239
    v_exp_f32 v224, v224
    v_exp_f32 v240, v240
    v_exp_f32 v225, v225
    v_exp_f32 v241, v241
    v_exp_f32 v226, v226
    v_exp_f32 v242, v242
    v_exp_f32 v227, v227
    v_exp_f32 v243, v243
    v_exp_f32 v228, v228
    v_exp_f32 v244, v244
    v_exp_f32 v229, v229
    v_exp_f32 v245, v245
    v_exp_f32 v230, v230
    v_exp_f32 v246, v246
    v_exp_f32 v231, v231
    v_exp_f32 v247, v247
    ds_write_b128 v178, v[96:99] offset:0
    ds_write_b128 v178, v[100:103] offset:1152
    ds_write_b128 v178, v[104:107] offset:2304
    ds_write_b128 v178, v[108:111] offset:3456
    ds_write_b128 v178, v[112:115] offset:4608
    ds_write_b128 v178, v[116:119] offset:5760
    ds_write_b128 v178, v[120:123] offset:6912
    ds_write_b128 v178, v[124:127] offset:8064
    v_pk_add_f32 v[16:17], v[216:217], v[218:219]
    v_pk_add_f32 v[18:19], v[232:233], v[234:235]
    v_pk_add_f32 v[20:21], v[228:229], v[230:231]
    v_pk_add_f32 v[22:23], v[244:245], v[246:247]
    v_pk_add_f32 v[16:17], v[16:17], v[220:221]
    v_pk_add_f32 v[18:19], v[18:19], v[236:237]
    v_pk_add_f32 v[16:17], v[16:17], v[222:223]
    v_pk_add_f32 v[18:19], v[18:19], v[238:239]
    v_pk_add_f32 v[16:17], v[16:17], v[224:225]
    v_pk_add_f32 v[18:19], v[18:19], v[240:241]
    v_pk_add_f32 v[16:17], v[16:17], v[226:227]
    v_pk_add_f32 v[18:19], v[18:19], v[242:243]
    v_pk_fma_f32 v[16:17], v[20:21], v[26:27], v[16:17] op_sel:[0,0,0] op_sel_hi:[1,0,1]
    v_pk_fma_f32 v[18:19], v[22:23], v[26:27], v[18:19] op_sel:[0,0,0] op_sel_hi:[1,0,1]
    v_add_f32 v16, v16, v17
    v_add_f32 v18, v18, v19
    v_mov_b32 v17, v16
    v_mov_b32 v19, v18
    s_nop 1
    v_permlane32_swap_b32 v16, v17
    v_permlane32_swap_b32 v18, v19
    s_nop 0
    v_add_f32 v16, v16, v17
    v_add_f32 v18, v18, v19
    v_rcp_f32 v16, v16
    v_rcp_f32 v18, v18
    s_nop 0
    v_mul_f32 v17, v26, v16
    v_mul_f32 v19, v26, v18
    v_pk_mul_f32 v[216:217], v[216:217], v[16:17] op_sel:[0,0] op_sel_hi:[1,0]
    v_pk_mul_f32 v[232:233], v[232:233], v[18:19] op_sel:[0,0] op_sel_hi:[1,0]
    v_pk_mul_f32 v[218:219], v[218:219], v[16:17] op_sel:[0,0] op_sel_hi:[1,0]
    v_pk_mul_f32 v[234:235], v[234:235], v[18:19] op_sel:[0,0] op_sel_hi:[1,0]
    v_pk_mul_f32 v[220:221], v[220:221], v[16:17] op_sel:[0,0] op_sel_hi:[1,0]
    v_pk_mul_f32 v[236:237], v[236:237], v[18:19] op_sel:[0,0] op_sel_hi:[1,0]
    v_pk_mul_f32 v[222:223], v[222:223], v[16:17] op_sel:[0,0] op_sel_hi:[1,0]
    v_pk_mul_f32 v[238:239], v[238:239], v[18:19] op_sel:[0,0] op_sel_hi:[1,0]
    v_pk_mul_f32 v[224:225], v[224:225], v[16:17] op_sel:[0,0] op_sel_hi:[1,0]
    v_pk_mul_f32 v[240:241], v[240:241], v[18:19] op_sel:[0,0] op_sel_hi:[1,0]
    v_pk_mul_f32 v[226:227], v[226:227], v[16:17] op_sel:[0,0] op_sel_hi:[1,0]
    v_pk_mul_f32 v[242:243], v[242:243], v[18:19] op_sel:[0,0] op_sel_hi:[1,0]
    v_pk_mul_f32 v[228:229], v[228:229], v[16:17] op_sel:[0,1] op_sel_hi:[1,1]
    v_pk_mul_f32 v[244:245], v[244:245], v[18:19] op_sel:[0,1] op_sel_hi:[1,1]
    v_pk_mul_f32 v[230:231], v[230:231], v[16:17] op_sel:[0,1] op_sel_hi:[1,1]
    v_pk_mul_f32 v[246:247], v[246:247], v[18:19] op_sel:[0,1] op_sel_hi:[1,1]
    v_cvt_pk_bf16_f32 v200, v216, v217
    v_cvt_pk_bf16_f32 v201, v218, v219
    v_cvt_pk_bf16_f32 v202, v220, v221
    v_cvt_pk_bf16_f32 v203, v222, v223
    v_cvt_pk_bf16_f32 v204, v224, v225
    v_cvt_pk_bf16_f32 v205, v226, v227
    v_cvt_pk_bf16_f32 v206, v228, v229
    v_cvt_pk_bf16_f32 v207, v230, v231
    v_cvt_pk_bf16_f32 v208, v232, v233
    v_cvt_pk_bf16_f32 v209, v234, v235
    v_cvt_pk_bf16_f32 v210, v236, v237
    v_cvt_pk_bf16_f32 v211, v238, v239
    v_cvt_pk_bf16_f32 v212, v240, v241
    v_cvt_pk_bf16_f32 v213, v242, v243
    v_cvt_pk_bf16_f32 v214, v244, v245
    v_cvt_pk_bf16_f32 v215, v246, v247
    s_nop 1
    buffer_store_dwordx4 v[200:203], v180, s[60:63], s64 offen offset:0
    buffer_store_dwordx4 v[204:207], v180, s[60:63], s64 offen offset:1024
    buffer_store_dwordx4 v[208:211], v180, s[60:63], s64 offen offset:2048
    buffer_store_dwordx4 v[212:215], v180, s[60:63], s64 offen offset:3072
    s_cmp_lg_u32 s38, 0
    s_cbranch_scc1 A1_r_6
    s_waitcnt vmcnt(4)
A1_q_5:
    v_readfirstlane_b32 s42, v177
    s_cmp_lg_u32 s42, 0
    s_cbranch_scc1 A1_r_6
    global_load_dword v177, v182, s[32:33] offset:64 sc1
    s_waitcnt vmcnt(0)
    s_branch A1_q_5
A1_r_6:
    s_waitcnt lgkmcnt(0)
    s_barrier
    ds_read_b64 v[64:65], v179 offset:0
    ds_read_b64 v[66:67], v179 offset:9216
    ds_read_b64 v[68:69], v179 offset:18432
    ds_read_b64 v[70:71], v179 offset:27648
    ds_read_b64 v[72:73], v179 offset:256
    ds_read_b64 v[74:75], v179 offset:9472
    ds_read_b64 v[76:77], v179 offset:18688
    ds_read_b64 v[78:79], v179 offset:27904
    ds_read_b64 v[80:81], v179 offset:512
    ds_read_b64 v[82:83], v179 offset:9728
    ds_read_b64 v[84:85], v179 offset:18944
    ds_read_b64 v[86:87], v179 offset:28160
    s_waitcnt lgkmcnt(8)
    v_pk_add_f32 v[64:65], v[64:65], v[66:67]
    v_pk_add_f32 v[68:69], v[68:69], v[70:71]
    v_pk_add_f32 v[64:65], v[64:65], v[68:69]
    v_cvt_pk_bf16_f32 v64, v64, v65
    buffer_atomic_pk_add_bf16 v64, v181, s[60:63], 0 offen offset:0
    ds_read_b64 v[88:89], v179 offset:768
    ds_read_b64 v[90:91], v179 offset:9984
    ds_read_b64 v[92:93], v179 offset:19200
    ds_read_b64 v[94:95], v179 offset:28416
    s_waitcnt lgkmcnt(8)
    v_pk_add_f32 v[72:73], v[72:73], v[74:75]
    v_pk_add_f32 v[76:77], v[76:77], v[78:79]
    v_pk_add_f32 v[72:73], v[72:73], v[76:77]
    v_cvt_pk_bf16_f32 v72, v72, v73
    buffer_atomic_pk_add_bf16 v72, v181, s[60:63], 0 offen offset:256
    s_waitcnt lgkmcnt(4)
    v_pk_add_f32 v[80:81], v[80:81], v[82:83]
    v_pk_add_f32 v[84:85], v[84:85], v[86:87]
    v_pk_add_f32 v[80:81], v[80:81], v[84:85]
    v_cvt_pk_bf16_f32 v80, v80, v81
    buffer_atomic_pk_add_bf16 v80, v181, s[60:63], 0 offen offset:512
    s_waitcnt lgkmcnt(0)
    v_pk_add_f32 v[88:89], v[88:89], v[90:91]
    v_pk_add_f32 v[92:93], v[92:93], v[94:95]
    v_pk_add_f32 v[88:89], v[88:89], v[92:93]
    v_cvt_pk_bf16_f32 v88, v88, v89
    buffer_atomic_pk_add_bf16 v88, v181, s[60:63], 0 offen offset:768
    s_endpgm
L1_B:
    s_sub_u32 s41, s2, 128
    s_and_b32 s42, s41, 7
    s_mul_i32 s42, s42, 14
    s_lshr_b32 s41, s41, 3
    s_add_u32 s36, s41, s42
    s_lshl_b32 s37, s36, 2
    v_lshrrev_b32 v52, 6, v0
    v_and_b32 v1, 63, v0
    s_nop 0
    v_readfirstlane_b32 s38, v52
    s_lshl_b32 s41, s36, 3
    s_waitcnt lgkmcnt(0)
    s_load_dwordx2 s[48:49], s[26:27], s41
    s_load_dwordx2 s[54:55], s[28:29], s41
    s_lshr_b32 s39, s38, 1
    s_and_b32 s40, s38, 1
    s_add_u32 s41, s37, s39
    s_lshl_b32 s41, s41, 9
    s_lshl_b32 s42, s40, 8
    s_add_u32 s41, s41, s42
    v_lshl_add_u32 v52, v1, 2, s41
    global_load_dword v2, v52, s[14:15]
    global_load_dword v3, v52, s[16:17]
    global_load_dword v4, v52, s[18:19]
    global_load_dword v5, v52, s[20:21]
    global_load_dword v6, v52, s[22:23]
    global_load_dword v7, v52, s[24:25]
    s_sub_u32 s41, s2, 128
    s_lshr_b32 s41, s41, 3
    s_and_b32 s56, s41, 3
    s_lshr_b32 s41, s41, 2
    s_lshl_b32 s41, s41, 7
    v_add_u32 v254, s41, v0
    v_and_b32 v254, 511, v254
    s_movk_i32 s42, 3584
    s_lshl_b32 s41, s36, 3
    v_mul_lo_u32 v253, v254, s42
    v_add_u32 v253, s41, v253
    s_mov_b32 s44, s34
    s_mov_b32 s45, s35
    s_mov_b32 s46, 268435456
    s_mov_b32 s47, 0x00020000
    v_mov_b32 v60, 0
    v_mov_b32 v61, 0
    v_mov_b32 v62, 0
    v_mov_b32 v63, 0
    v_lshlrev_b32 v52, 4, v0
    v_add_u32 v52, 135936, v52
    ds_write_b128 v52, v[60:63]
    v_subrev_u32 v53, 288, v0
    v_lshrrev_b32 v54, 5, v53
    v_and_b32 v53, 31, v53
    v_mul_u32_u24 v54, 4608, v54
    v_lshl_add_u32 v54, v53, 4, v54
    v_add_u32 v54, 117504, v54
    v_add_u32 v55, 8192, v52
    v_cmp_gt_u32 vcc, 288, v0
    s_nop 1
    v_cndmask_b32 v54, v54, v55, vcc
    v_cmp_gt_u32 vcc, 416, v0
    s_nop 1
    v_cndmask_b32 v54, v52, v54, vcc
    ds_write_b128 v54, v[60:63]
    s_mul_i32 s41, s38, 5984
    s_add_u32 s41, s41, 66048
    v_and_b32 v52, 31, v1
    v_lshrrev_b32 v53, 5, v1
    v_mul_u32_u24 v40, 272, v52
    v_lshl_add_u32 v40, v53, 4, v40
    s_lshl_b32 s42, s38, 8
    v_mul_u32_u24 v39, 2064, v52
    v_lshl_add_u32 v39, v53, 4, v39
    v_add_u32 v39, s42, v39
    v_add_u32 v40, s41, v40
    s_mul_i32 s42, s39, 3200
    s_add_u32 s42, s42, 135952
    v_lshlrev_b32 v41, 5, v52
    v_lshl_add_u32 v41, v53, 4, v41
    v_add_u32 v41, s42, v41
    v_lshlrev_b32 v42, 4, v52
    v_lshl_add_u32 v42, v53, 3, v42
    v_add_u32 v42, s42, v42
    v_lshlrev_b32 v43, 3, v52
    v_lshl_add_u32 v43, v53, 2, v43
    v_add_u32 v43, s42, v43
    v_lshlrev_b32 v44, 2, v52
    v_lshl_add_u32 v44, v53, 7, v44
    v_add_u32 v44, s42, v44
    v_lshlrev_b32 v45, 2, v1
    v_add_u32 v45, 2600, v45
    v_mov_b32 v54, 2560
    v_cmp_eq_u32 vcc, 0, v1
    s_nop 1
    v_cndmask_b32 v45, v45, v54, vcc
    v_add_u32 v45, s42, v45
    s_lshl_b32 s43, s40, 6
    v_add_u32 v52, s43, v1
    s_mul_i32 s41, s39, 16640
    v_lshl_add_u32 v38, v52, 4, s41
    v_lshlrev_b32 v52, 3, v52
    s_sub_u32 s43, s42, 68096
    v_sub_u32 v53, 2047, v52
    v_subrev_u32 v54, 0, v53
    v_cvt_f32_i32 v55, v54
    v_subrev_u32 v56, 1, v53
    v_cvt_f32_i32 v57, v56
    v_cvt_pk_bf16_f32 v58, v55, v57
    v_and_b32 v59, 0xffff, v58
    v_lshl_add_u32 v16, v59, 2, s43
    v_lshrrev_b32 v59, 16, v58
    v_lshl_add_u32 v17, v59, 2, s43
    v_subrev_u32 v54, 2, v53
    v_cvt_f32_i32 v55, v54
    v_subrev_u32 v56, 3, v53
    v_cvt_f32_i32 v57, v56
    v_cvt_pk_bf16_f32 v58, v55, v57
    v_and_b32 v59, 0xffff, v58
    v_lshl_add_u32 v18, v59, 2, s43
    v_lshrrev_b32 v59, 16, v58
    v_lshl_add_u32 v19, v59, 2, s43
    v_subrev_u32 v54, 4, v53
    v_cvt_f32_i32 v55, v54
    v_subrev_u32 v56, 5, v53
    v_cvt_f32_i32 v57, v56
    v_cvt_pk_bf16_f32 v58, v55, v57
    v_and_b32 v59, 0xffff, v58
    v_lshl_add_u32 v20, v59, 2, s43
    v_lshrrev_b32 v59, 16, v58
    v_lshl_add_u32 v21, v59, 2, s43
    v_subrev_u32 v54, 6, v53
    v_cvt_f32_i32 v55, v54
    v_subrev_u32 v56, 7, v53
    v_cvt_f32_i32 v57, v56
    v_cvt_pk_bf16_f32 v58, v55, v57
    v_and_b32 v59, 0xffff, v58
    v_lshl_add_u32 v22, v59, 2, s43
    v_lshrrev_b32 v59, 16, v58
    v_lshl_add_u32 v23, v59, 2, s43
    v_subrev_u32 v54, 8, v53
    v_cvt_f32_i32 v55, v54
    v_subrev_u32 v56, 9, v53
    v_cvt_f32_i32 v57, v56
    v_cvt_pk_bf16_f32 v58, v55, v57
    v_and_b32 v59, 0xffff, v58
    v_lshl_add_u32 v24, v59, 2, s43
    v_lshrrev_b32 v59, 16, v58
    v_lshl_add_u32 v25, v59, 2, s43
    v_subrev_u32 v54, 10, v53
    v_cvt_f32_i32 v55, v54
    v_cvt_pk_bf16_f32 v58, v55, v55
    v_and_b32 v59, 0xffff, v58
    v_lshl_add_u32 v26, v59, 2, s43
    v_sub_u32 v53, 1023, v52
    v_subrev_u32 v54, 0, v53
    v_cvt_f32_i32 v55, v54
    v_subrev_u32 v56, 1, v53
    v_cvt_f32_i32 v57, v56
    v_cvt_pk_bf16_f32 v58, v55, v57
    v_and_b32 v59, 0xffff, v58
    v_lshl_add_u32 v27, v59, 2, s43
    v_lshrrev_b32 v59, 16, v58
    v_lshl_add_u32 v28, v59, 2, s43
    v_cmp_ge_i32 vcc, 256, v54
    v_lshl_add_u32 v59, v54, 2, s42
    s_nop 0
    v_cndmask_b32 v27, v27, v59, vcc
    v_cmp_ge_i32 vcc, 256, v56
    v_lshl_add_u32 v59, v56, 2, s42
    s_nop 0
    v_cndmask_b32 v28, v28, v59, vcc
    v_subrev_u32 v54, 2, v53
    v_cvt_f32_i32 v55, v54
    v_subrev_u32 v56, 3, v53
    v_cvt_f32_i32 v57, v56
    v_cvt_pk_bf16_f32 v58, v55, v57
    v_and_b32 v59, 0xffff, v58
    v_lshl_add_u32 v29, v59, 2, s43
    v_lshrrev_b32 v59, 16, v58
    v_lshl_add_u32 v30, v59, 2, s43
    v_cmp_ge_i32 vcc, 256, v54
    v_lshl_add_u32 v59, v54, 2, s42
    s_nop 0
    v_cndmask_b32 v29, v29, v59, vcc
    v_cmp_ge_i32 vcc, 256, v56
    v_lshl_add_u32 v59, v56, 2, s42
    s_nop 0
    v_cndmask_b32 v30, v30, v59, vcc
    v_subrev_u32 v54, 4, v53
    v_cvt_f32_i32 v55, v54
    v_subrev_u32 v56, 5, v53
    v_cvt_f32_i32 v57, v56
    v_cvt_pk_bf16_f32 v58, v55, v57
    v_and_b32 v59, 0xffff, v58
    v_lshl_add_u32 v31, v59, 2, s43
    v_lshrrev_b32 v59, 16, v58
    v_lshl_add_u32 v32, v59, 2, s43
    v_cmp_ge_i32 vcc, 256, v54
    v_lshl_add_u32 v59, v54, 2, s42
    s_nop 0
    v_cndmask_b32 v31, v31, v59, vcc
    v_cmp_ge_i32 vcc, 256, v56
    v_lshl_add_u32 v59, v56, 2, s42
    s_nop 0
    v_cndmask_b32 v32, v32, v59, vcc
    v_subrev_u32 v54, 6, v53
    v_cvt_f32_i32 v55, v54
    v_subrev_u32 v56, 7, v53
    v_cvt_f32_i32 v57, v56
    v_cvt_pk_bf16_f32 v58, v55, v57
    v_and_b32 v59, 0xffff, v58
    v_lshl_add_u32 v33, v59, 2, s43
    v_lshrrev_b32 v59, 16, v58
    v_lshl_add_u32 v34, v59, 2, s43
    v_cmp_ge_i32 vcc, 256, v54
    v_lshl_add_u32 v59, v54, 2, s42
    s_nop 0
    v_cndmask_b32 v33, v33, v59, vcc
    v_cmp_ge_i32 vcc, 256, v56
    v_lshl_add_u32 v59, v56, 2, s42
    s_nop 0
    v_cndmask_b32 v34, v34, v59, vcc
    v_subrev_u32 v54, 8, v53
    v_cvt_f32_i32 v55, v54
    v_subrev_u32 v56, 9, v53
    v_cvt_f32_i32 v57, v56
    v_cvt_pk_bf16_f32 v58, v55, v57
    v_and_b32 v59, 0xffff, v58
    v_lshl_add_u32 v35, v59, 2, s43
    v_lshrrev_b32 v59, 16, v58
    v_lshl_add_u32 v36, v59, 2, s43
    v_cmp_ge_i32 vcc, 256, v54
    v_lshl_add_u32 v59, v54, 2, s42
    s_nop 0
    v_cndmask_b32 v35, v35, v59, vcc
    v_cmp_ge_i32 vcc, 256, v56
    v_lshl_add_u32 v59, v56, 2, s42
    s_nop 0
    v_cndmask_b32 v36, v36, v59, vcc
    v_subrev_u32 v54, 10, v53
    v_cvt_f32_i32 v55, v54
    v_cvt_pk_bf16_f32 v58, v55, v55
    v_and_b32 v59, 0xffff, v58
    v_lshl_add_u32 v37, v59, 2, s43
    v_cmp_ge_i32 vcc, 256, v54
    v_lshl_add_u32 v59, v54, 2, s42
    s_nop 0
    v_cndmask_b32 v37, v37, v59, vcc
    v_and_b32 v52, 15, v1
    v_lshrrev_b32 v53, 4, v1
    v_add_u32 v54, 1, v52
    v_and_b32 v54, 3, v54
    v_sub_u32 v55, 15, v52
    v_lshl_add_u32 v55, v53, 3, v55
    v_add_u32 v55, v55, v54
    v_add_u32 v56, -4, v55
    v_cmp_eq_u32 vcc, 0, v54
    v_mul_u32_u24 v57, 4160, v54
    s_nop 0
    v_cndmask_b32 v55, v56, v55, vcc
    v_lshl_add_u32 v46, v55, 1, v57
    s_mul_i32 s41, s39, 16640
    s_sub_u32 s42, 1, s40
    s_lshl_b32 s42, s42, 8
    s_add_u32 s41, s41, s42
    v_add_u32 v46, s41, v46
    v_lshlrev_b32 v47, 5, v52
    v_lshl_add_u32 v47, v53, 4, v47
    s_mul_i32 s41, s39, 4608
    s_lshl_b32 s42, s40, 8
    s_sub_u32 s41, s41, s42
    s_add_u32 s41, s41, 117792
    v_add_u32 v47, s41, v47
    s_lshl_b32 s41, s38, 12
    s_add_u32 s42, s41, 66560
    v_lshl_add_u32 v48, v1, 4, s42
    s_xor_b32 s41, s38, 1
    s_lshl_b32 s41, s41, 12
    s_add_u32 s42, s41, 66560
    v_lshl_add_u32 v49, v1, 4, s42
    s_add_u32 s41, s37, s39
    s_lshl_b32 s41, s41, 6
    s_mul_i32 s42, s40, 917504
    s_add_u32 s41, s41, s42
    v_bfe_u32 v50, v1, 4, 1
    v_bfe_u32 v56, v1, 1, 3
    v_lshl_add_u32 v50, v50, 3, v56
    v_mul_u32_u24 v50, 28672, v50
    v_and_b32 v56, 1, v1
    v_lshl_add_u32 v50, v56, 5, v50
    v_lshrrev_b32 v56, 5, v1
    v_lshl_add_u32 v50, v56, 4, v50
    v_add_u32 v50, s41, v50
    s_mov_b32 s50, 8388608
    s_mul_i32 s41, s39, 4608
    s_lshl_b32 s42, s40, 11
    s_add_u32 s41, s41, s42
    s_add_u32 s41, s41, 118016
    v_and_b32 v54, 1, v53
    v_lshlrev_b32 v54, 9, v54
    v_lshl_add_u32 v54, v52, 5, v54
    v_lshrrev_b32 v55, 1, v53
    v_lshl_add_u32 v54, v55, 4, v54
    v_add_u32 v252, s41, v54
    s_waitcnt lgkmcnt(0)
    s_barrier
    s_cmp_ge_u32 s39, 2
    s_cselect_b32 s41, s49, s48
    s_and_b32 s42, s39, 1
    s_lshl_b32 s42, s42, 4
    s_lshr_b32 s41, s41, s42
    s_lshl_b32 s41, s41, 16
    s_cmp_ge_u32 s39, 2
    s_cselect_b32 s54, s55, s54
    s_lshr_b32 s54, s54, s42
    s_lshl_b32 s54, s54, 16
    s_mov_b32 s55, s54
    v_mov_b32 v52, s41
    s_mov_b32 s42, 0x3fb8aa3b
    v_mul_f32 v53, s42, v52
    v_rndne_f32 v53, v53
    v_fma_f32 v54, v52, s42, -v53
    v_mov_b32 v55, 0x32a57060
    v_fma_f32 v54, v52, v55, v54
    v_exp_f32 v54, v54
    v_cvt_i32_f32 v53, v53
    s_nop 0
    v_ldexp_f32 v54, v54, v53
    v_cvt_pk_bf16_f32 v54, v54, v54
    v_lshlrev_b32 v51, 16, v54
    s_waitcnt vmcnt(0)
    s_add_u32 s41, s56, 0
    s_and_b32 s41, s41, 3
    s_mul_i32 s41, s41, 896
    v_add_u32 v64, s41, v253
    global_load_dwordx2 v[8:9], v64, s[12:13]
    v_lshlrev_b32 v52, 16, v2
    v_lshlrev_b32 v53, 16, v3
    v_lshlrev_b32 v54, 16, v4
    v_lshlrev_b32 v55, 16, v5
    v_lshlrev_b32 v56, 16, v6
    v_lshlrev_b32 v57, 16, v7
    v_mul_f32 v52, v51, v52
    v_mul_f32 v53, v51, v53
    v_mul_f32 v54, v51, v54
    v_mul_f32 v55, v51, v55
    v_mul_f32 v52, 1069066811, v52
    v_mul_f32 v53, 0.15915494, v53
    v_pk_mul_f32 v[84:85], v[56:57], v[54:55] op_sel:[0,0] op_sel_hi:[1,0]
    v_pk_fma_f32 v[84:85], v[56:57], v[54:55], v[84:85] op_sel:[1,1,0] op_sel_hi:[0,1,1] neg_lo:[1,0,0]
    v_xor_b32 v85, 0x80000000, v85
    v_exp_f32 v54, v52
    v_fract_f32 v55, v53
    v_cos_f32 v64, v55
    v_sin_f32 v65, v55
    s_nop 0
    v_mul_f32 v64, v54, v64
    v_mul_f32 v65, v54, v65
    v_mul_f32 v54, 0x41000000, v52
    v_mul_f32 v55, 0x41000000, v53
    v_exp_f32 v54, v54
    v_fract_f32 v55, v55
    v_cos_f32 v74, v55
    v_sin_f32 v75, v55
    s_nop 0
    v_mul_f32 v74, v54, v74
    v_mul_f32 v75, v54, v75
    v_mul_f32 v54, 0x43800000, v52
    v_mul_f32 v55, 0x43800000, v53
    v_exp_f32 v54, v54
    v_fract_f32 v55, v55
    v_cos_f32 v76, v55
    v_sin_f32 v77, v55
    s_nop 0
    v_mul_f32 v76, v54, v76
    v_mul_f32 v77, v54, v77
    s_mul_i32 s41, s38, 5984
    s_add_u32 m0, s41, 8192
    v_mov_b32 v59, 0x3f80
    s_nop 0
    ds_write_addtid_b32 v59 offset:57856
    v_pk_mul_f32 v[66:67], v[64:65], v[64:65] op_sel:[0,0] op_sel_hi:[1,0]
    v_pk_mul_f32 v[78:79], v[76:77], v[76:77] op_sel:[0,0] op_sel_hi:[1,0]
    v_cvt_pk_bf16_f32 v60, v64, v65
    v_cvt_pk_bf16_f32 v61, v76, v77
    v_pk_fma_f32 v[66:67], v[64:65], v[64:65], v[66:67] op_sel:[1,1,0] op_sel_hi:[0,1,1] neg_lo:[1,0,0]
    v_pk_fma_f32 v[78:79], v[76:77], v[76:77], v[78:79] op_sel:[1,1,0] op_sel_hi:[0,1,1] neg_lo:[1,0,0]
    ds_write_addtid_b32 v60 offset:58128
    ds_write_addtid_b32 v61 offset:60032
    v_pk_mul_f32 v[68:69], v[66:67], v[64:65] op_sel:[0,0] op_sel_hi:[1,0]
    v_pk_mul_f32 v[70:71], v[66:67], v[66:67] op_sel:[0,0] op_sel_hi:[1,0]
    v_cvt_pk_bf16_f32 v62, v66, v67
    v_cvt_pk_bf16_f32 v63, v78, v79
    v_pk_fma_f32 v[68:69], v[66:67], v[64:65], v[68:69] op_sel:[1,1,0] op_sel_hi:[0,1,1] neg_lo:[1,0,0]
    v_pk_fma_f32 v[70:71], v[66:67], v[66:67], v[70:71] op_sel:[1,1,0] op_sel_hi:[0,1,1] neg_lo:[1,0,0]
    ds_write_addtid_b32 v62 offset:58400
    ds_write_addtid_b32 v63 offset:60576
    v_pk_mul_f32 v[80:81], v[78:79], v[76:77] op_sel:[0,0] op_sel_hi:[1,0]
    v_pk_mul_f32 v[82:83], v[78:79], v[78:79] op_sel:[0,0] op_sel_hi:[1,0]
    v_cvt_pk_bf16_f32 v60, v68, v69
    v_cvt_pk_bf16_f32 v61, v70, v71
    v_pk_fma_f32 v[80:81], v[78:79], v[76:77], v[80:81] op_sel:[1,1,0] op_sel_hi:[0,1,1] neg_lo:[1,0,0]
    v_pk_fma_f32 v[82:83], v[78:79], v[78:79], v[82:83] op_sel:[1,1,0] op_sel_hi:[0,1,1] neg_lo:[1,0,0]
    ds_write_addtid_b32 v60 offset:58672
    ds_write_addtid_b32 v61 offset:58944
    v_pk_mul_f32 v[88:89], v[70:71], v[64:65] op_sel:[0,0] op_sel_hi:[1,0]
    v_pk_mul_f32 v[72:73], v[68:69], v[68:69] op_sel:[0,0] op_sel_hi:[1,0]
    v_cvt_pk_bf16_f32 v62, v80, v81
    v_cvt_pk_bf16_f32 v63, v82, v83
    v_pk_fma_f32 v[88:89], v[70:71], v[64:65], v[88:89] op_sel:[1,1,0] op_sel_hi:[0,1,1] neg_lo:[1,0,0]
    v_pk_fma_f32 v[72:73], v[68:69], v[68:69], v[72:73] op_sel:[1,1,0] op_sel_hi:[0,1,1] neg_lo:[1,0,0]
    ds_write_addtid_b32 v62 offset:60848
    ds_write_addtid_b32 v63 offset:62208
    v_pk_mul_f32 v[90:91], v[70:71], v[68:69] op_sel:[0,0] op_sel_hi:[1,0]
    v_pk_mul_f32 v[86:87], v[76:77], v[66:67] op_sel:[0,0] op_sel_hi:[1,0]
    v_cvt_pk_bf16_f32 v60, v88, v89
    v_cvt_pk_bf16_f32 v61, v72, v73
    v_pk_fma_f32 v[90:91], v[70:71], v[68:69], v[90:91] op_sel:[1,1,0] op_sel_hi:[0,1,1] neg_lo:[1,0,0]
    v_pk_fma_f32 v[86:87], v[76:77], v[66:67], v[86:87] op_sel:[1,1,0] op_sel_hi:[0,1,1] neg_lo:[1,0,0]
    ds_write_addtid_b32 v60 offset:59216
    ds_write_addtid_b32 v61 offset:59488
    v_pk_mul_f32 v[88:89], v[76:77], v[70:71] op_sel:[0,0] op_sel_hi:[1,0]
    v_pk_mul_f32 v[68:69], v[76:77], v[72:73] op_sel:[0,0] op_sel_hi:[1,0]
    v_cvt_pk_bf16_f32 v62, v90, v91
    v_cvt_pk_bf16_f32 v63, v86, v87
    v_pk_fma_f32 v[88:89], v[76:77], v[70:71], v[88:89] op_sel:[1,1,0] op_sel_hi:[0,1,1] neg_lo:[1,0,0]
    v_pk_fma_f32 v[68:69], v[76:77], v[72:73], v[68:69] op_sel:[1,1,0] op_sel_hi:[0,1,1] neg_lo:[1,0,0]
    ds_write_addtid_b32 v62 offset:59760
    ds_write_addtid_b32 v63 offset:60304
    v_pk_mul_f32 v[90:91], v[78:79], v[70:71] op_sel:[0,0] op_sel_hi:[1,0]
    v_pk_mul_f32 v[86:87], v[80:81], v[70:71] op_sel:[0,0] op_sel_hi:[1,0]
    v_cvt_pk_bf16_f32 v60, v88, v89
    v_cvt_pk_bf16_f32 v61, v68, v69
    v_pk_fma_f32 v[90:91], v[78:79], v[70:71], v[90:91] op_sel:[1,1,0] op_sel_hi:[0,1,1] neg_lo:[1,0,0]
    v_pk_fma_f32 v[86:87], v[80:81], v[70:71], v[86:87] op_sel:[1,1,0] op_sel_hi:[0,1,1] neg_lo:[1,0,0]
    ds_write_addtid_b32 v60 offset:61120
    ds_write_addtid_b32 v61 offset:61392
    v_pk_mul_f32 v[88:89], v[82:83], v[76:77] op_sel:[0,0] op_sel_hi:[1,0]
    v_pk_mul_f32 v[68:69], v[82:83], v[78:79] op_sel:[0,0] op_sel_hi:[1,0]
    v_cvt_pk_bf16_f32 v62, v90, v91
    v_cvt_pk_bf16_f32 v63, v86, v87
    v_pk_fma_f32 v[88:89], v[82:83], v[76:77], v[88:89] op_sel:[1,1,0] op_sel_hi:[0,1,1] neg_lo:[1,0,0]
    v_pk_fma_f32 v[68:69], v[82:83], v[78:79], v[68:69] op_sel:[1,1,0] op_sel_hi:[0,1,1] neg_lo:[1,0,0]
    ds_write_addtid_b32 v62 offset:61664
    ds_write_addtid_b32 v63 offset:61936
    v_pk_mul_f32 v[90:91], v[82:83], v[80:81] op_sel:[0,0] op_sel_hi:[1,0]
    v_pk_mul_f32 v[70:71], v[82:83], v[82:83] op_sel:[0,0] op_sel_hi:[1,0]
    v_cvt_pk_bf16_f32 v60, v88, v89
    v_cvt_pk_bf16_f32 v61, v68, v69
    v_pk_fma_f32 v[90:91], v[82:83], v[80:81], v[90:91] op_sel:[1,1,0] op_sel_hi:[0,1,1] neg_lo:[1,0,0]
    v_pk_fma_f32 v[70:71], v[82:83], v[82:83], v[70:71] op_sel:[1,1,0] op_sel_hi:[0,1,1] neg_lo:[1,0,0]
    ds_write_addtid_b32 v60 offset:63296
    ds_write_addtid_b32 v61 offset:62480
    v_pk_mul_f32 v[86:87], v[84:85], v[74:75] op_sel:[0,0] op_sel_hi:[1,0]
    v_pk_mul_f32 v[66:67], v[74:75], v[74:75] op_sel:[0,0] op_sel_hi:[1,0]
    v_cvt_pk_bf16_f32 v62, v90, v91
    v_cvt_pk_bf16_f32 v63, v70, v71
    v_pk_fma_f32 v[86:87], v[84:85], v[74:75], v[86:87] op_sel:[1,1,0] op_sel_hi:[0,1,1] neg_hi:[1,0,0]
    v_pk_fma_f32 v[66:67], v[74:75], v[74:75], v[66:67] op_sel:[1,1,0] op_sel_hi:[0,1,1] neg_lo:[1,0,0]
    ds_write_addtid_b32 v62 offset:63568
    ds_write_addtid_b32 v63 offset:62752
    s_lshl_b32 m0, s38, 8
    v_pk_mul_f32 v[88:89], v[84:85], v[66:67] op_sel:[0,0] op_sel_hi:[1,0]
    v_pk_mul_f32 v[90:91], v[86:87], v[66:67] op_sel:[0,0] op_sel_hi:[1,0]
    v_cvt_pk_bf16_f32 v60, v84, v85
    v_cvt_pk_bf16_f32 v61, v86, v87
    v_pk_fma_f32 v[88:89], v[84:85], v[66:67], v[88:89] op_sel:[1,1,0] op_sel_hi:[0,1,1] neg_hi:[1,0,0]
    v_pk_fma_f32 v[90:91], v[86:87], v[66:67], v[90:91] op_sel:[1,1,0] op_sel_hi:[0,1,1] neg_hi:[1,0,0]
    ds_write_addtid_b32 v60 offset:0
    ds_write_addtid_b32 v61 offset:2064
    v_pk_mul_f32 v[84:85], v[88:89], v[66:67] op_sel:[0,0] op_sel_hi:[1,0]
    v_pk_mul_f32 v[86:87], v[90:91], v[66:67] op_sel:[0,0] op_sel_hi:[1,0]
    v_cvt_pk_bf16_f32 v62, v88, v89
    v_cvt_pk_bf16_f32 v63, v90, v91
    v_pk_fma_f32 v[84:85], v[88:89], v[66:67], v[84:85] op_sel:[1,1,0] op_sel_hi:[0,1,1] neg_hi:[1,0,0]
    v_pk_fma_f32 v[86:87], v[90:91], v[66:67], v[86:87] op_sel:[1,1,0] op_sel_hi:[0,1,1] neg_hi:[1,0,0]
    ds_write_addtid_b32 v62 offset:4128
    ds_write_addtid_b32 v63 offset:6192
    v_pk_mul_f32 v[88:89], v[84:85], v[66:67] op_sel:[0,0] op_sel_hi:[1,0]
    v_pk_mul_f32 v[90:91], v[86:87], v[66:67] op_sel:[0,0] op_sel_hi:[1,0]
    v_cvt_pk_bf16_f32 v60, v84, v85
    v_cvt_pk_bf16_f32 v61, v86, v87
    v_pk_fma_f32 v[88:89], v[84:85], v[66:67], v[88:89] op_sel:[1,1,0] op_sel_hi:[0,1,1] neg_hi:[1,0,0]
    v_pk_fma_f32 v[90:91], v[86:87], v[66:67], v[90:91] op_sel:[1,1,0] op_sel_hi:[0,1,1] neg_hi:[1,0,0]
    ds_write_addtid_b32 v60 offset:8256
    ds_write_addtid_b32 v61 offset:10320
    v_pk_mul_f32 v[84:85], v[88:89], v[66:67] op_sel:[0,0] op_sel_hi:[1,0]
    v_pk_mul_f32 v[86:87], v[90:91], v[66:67] op_sel:[0,0] op_sel_hi:[1,0]
    v_cvt_pk_bf16_f32 v62, v88, v89
    v_cvt_pk_bf16_f32 v63, v90, v91
    v_pk_fma_f32 v[84:85], v[88:89], v[66:67], v[84:85] op_sel:[1,1,0] op_sel_hi:[0,1,1] neg_hi:[1,0,0]
    v_pk_fma_f32 v[86:87], v[90:91], v[66:67], v[86:87] op_sel:[1,1,0] op_sel_hi:[0,1,1] neg_hi:[1,0,0]
    ds_write_addtid_b32 v62 offset:12384
    ds_write_addtid_b32 v63 offset:14448
    v_pk_mul_f32 v[88:89], v[84:85], v[66:67] op_sel:[0,0] op_sel_hi:[1,0]
    v_pk_mul_f32 v[90:91], v[86:87], v[66:67] op_sel:[0,0] op_sel_hi:[1,0]
    v_cvt_pk_bf16_f32 v60, v84, v85
    v_cvt_pk_bf16_f32 v61, v86, v87
    v_pk_fma_f32 v[88:89], v[84:85], v[66:67], v[88:89] op_sel:[1,1,0] op_sel_hi:[0,1,1] neg_hi:[1,0,0]
    v_pk_fma_f32 v[90:91], v[86:87], v[66:67], v[90:91] op_sel:[1,1,0] op_sel_hi:[0,1,1] neg_hi:[1,0,0]
    ds_write_addtid_b32 v60 offset:16512
    ds_write_addtid_b32 v61 offset:18576
    v_pk_mul_f32 v[84:85], v[88:89], v[66:67] op_sel:[0,0] op_sel_hi:[1,0]
    v_pk_mul_f32 v[86:87], v[90:91], v[66:67] op_sel:[0,0] op_sel_hi:[1,0]
    v_cvt_pk_bf16_f32 v62, v88, v89
    v_cvt_pk_bf16_f32 v63, v90, v91
    v_pk_fma_f32 v[84:85], v[88:89], v[66:67], v[84:85] op_sel:[1,1,0] op_sel_hi:[0,1,1] neg_hi:[1,0,0]
    v_pk_fma_f32 v[86:87], v[90:91], v[66:67], v[86:87] op_sel:[1,1,0] op_sel_hi:[0,1,1] neg_hi:[1,0,0]
    ds_write_addtid_b32 v62 offset:20640
    ds_write_addtid_b32 v63 offset:22704
    s_add_u32 s41, s56, 1
    s_and_b32 s41, s41, 3
    s_mul_i32 s41, s41, 896
    v_add_u32 v64, s41, v253
    global_load_dwordx2 v[10:11], v64, s[12:13]
    v_pk_mul_f32 v[88:89], v[84:85], v[66:67] op_sel:[0,0] op_sel_hi:[1,0]
    v_pk_mul_f32 v[90:91], v[86:87], v[66:67] op_sel:[0,0] op_sel_hi:[1,0]
    v_cvt_pk_bf16_f32 v60, v84, v85
    v_cvt_pk_bf16_f32 v61, v86, v87
    v_pk_fma_f32 v[88:89], v[84:85], v[66:67], v[88:89] op_sel:[1,1,0] op_sel_hi:[0,1,1] neg_hi:[1,0,0]
    v_pk_fma_f32 v[90:91], v[86:87], v[66:67], v[90:91] op_sel:[1,1,0] op_sel_hi:[0,1,1] neg_hi:[1,0,0]
    ds_write_addtid_b32 v60 offset:24768
    ds_write_addtid_b32 v61 offset:26832
    v_pk_mul_f32 v[84:85], v[88:89], v[66:67] op_sel:[0,0] op_sel_hi:[1,0]
    v_pk_mul_f32 v[86:87], v[90:91], v[66:67] op_sel:[0,0] op_sel_hi:[1,0]
    v_cvt_pk_bf16_f32 v62, v88, v89
    v_cvt_pk_bf16_f32 v63, v90, v91
    v_pk_fma_f32 v[84:85], v[88:89], v[66:67], v[84:85] op_sel:[1,1,0] op_sel_hi:[0,1,1] neg_hi:[1,0,0]
    v_pk_fma_f32 v[86:87], v[90:91], v[66:67], v[86:87] op_sel:[1,1,0] op_sel_hi:[0,1,1] neg_hi:[1,0,0]
    ds_write_addtid_b32 v62 offset:28896
    ds_write_addtid_b32 v63 offset:30960
    v_pk_mul_f32 v[88:89], v[84:85], v[66:67] op_sel:[0,0] op_sel_hi:[1,0]
    v_pk_mul_f32 v[90:91], v[86:87], v[66:67] op_sel:[0,0] op_sel_hi:[1,0]
    v_cvt_pk_bf16_f32 v60, v84, v85
    v_cvt_pk_bf16_f32 v61, v86, v87
    v_pk_fma_f32 v[88:89], v[84:85], v[66:67], v[88:89] op_sel:[1,1,0] op_sel_hi:[0,1,1] neg_hi:[1,0,0]
    v_pk_fma_f32 v[90:91], v[86:87], v[66:67], v[90:91] op_sel:[1,1,0] op_sel_hi:[0,1,1] neg_hi:[1,0,0]
    ds_write_addtid_b32 v60 offset:33024
    ds_write_addtid_b32 v61 offset:35088
    v_pk_mul_f32 v[84:85], v[88:89], v[66:67] op_sel:[0,0] op_sel_hi:[1,0]
    v_pk_mul_f32 v[86:87], v[90:91], v[66:67] op_sel:[0,0] op_sel_hi:[1,0]
    v_cvt_pk_bf16_f32 v62, v88, v89
    v_cvt_pk_bf16_f32 v63, v90, v91
    v_pk_fma_f32 v[84:85], v[88:89], v[66:67], v[84:85] op_sel:[1,1,0] op_sel_hi:[0,1,1] neg_hi:[1,0,0]
    v_pk_fma_f32 v[86:87], v[90:91], v[66:67], v[86:87] op_sel:[1,1,0] op_sel_hi:[0,1,1] neg_hi:[1,0,0]
    ds_write_addtid_b32 v62 offset:37152
    ds_write_addtid_b32 v63 offset:39216
    v_pk_mul_f32 v[88:89], v[84:85], v[66:67] op_sel:[0,0] op_sel_hi:[1,0]
    v_pk_mul_f32 v[90:91], v[86:87], v[66:67] op_sel:[0,0] op_sel_hi:[1,0]
    v_cvt_pk_bf16_f32 v60, v84, v85
    v_cvt_pk_bf16_f32 v61, v86, v87
    v_pk_fma_f32 v[88:89], v[84:85], v[66:67], v[88:89] op_sel:[1,1,0] op_sel_hi:[0,1,1] neg_hi:[1,0,0]
    v_pk_fma_f32 v[90:91], v[86:87], v[66:67], v[90:91] op_sel:[1,1,0] op_sel_hi:[0,1,1] neg_hi:[1,0,0]
    ds_write_addtid_b32 v60 offset:41280
    ds_write_addtid_b32 v61 offset:43344
    v_pk_mul_f32 v[84:85], v[88:89], v[66:67] op_sel:[0,0] op_sel_hi:[1,0]
    v_pk_mul_f32 v[86:87], v[90:91], v[66:67] op_sel:[0,0] op_sel_hi:[1,0]
    v_cvt_pk_bf16_f32 v62, v88, v89
    v_cvt_pk_bf16_f32 v63, v90, v91
    v_pk_fma_f32 v[84:85], v[88:89], v[66:67], v[84:85] op_sel:[1,1,0] op_sel_hi:[0,1,1] neg_hi:[1,0,0]
    v_pk_fma_f32 v[86:87], v[90:91], v[66:67], v[86:87] op_sel:[1,1,0] op_sel_hi:[0,1,1] neg_hi:[1,0,0]
    ds_write_addtid_b32 v62 offset:45408
    ds_write_addtid_b32 v63 offset:47472
    v_pk_mul_f32 v[88:89], v[84:85], v[66:67] op_sel:[0,0] op_sel_hi:[1,0]
    v_pk_mul_f32 v[90:91], v[86:87], v[66:67] op_sel:[0,0] op_sel_hi:[1,0]
    v_cvt_pk_bf16_f32 v60, v84, v85
    v_cvt_pk_bf16_f32 v61, v86, v87
    v_pk_fma_f32 v[88:89], v[84:85], v[66:67], v[88:89] op_sel:[1,1,0] op_sel_hi:[0,1,1] neg_hi:[1,0,0]
    v_pk_fma_f32 v[90:91], v[86:87], v[66:67], v[90:91] op_sel:[1,1,0] op_sel_hi:[0,1,1] neg_hi:[1,0,0]
    ds_write_addtid_b32 v60 offset:49536
    ds_write_addtid_b32 v61 offset:51600
    v_pk_mul_f32 v[84:85], v[88:89], v[66:67] op_sel:[0,0] op_sel_hi:[1,0]
    v_pk_mul_f32 v[86:87], v[90:91], v[66:67] op_sel:[0,0] op_sel_hi:[1,0]
    v_cvt_pk_bf16_f32 v62, v88, v89
    v_cvt_pk_bf16_f32 v63, v90, v91
    v_pk_fma_f32 v[84:85], v[88:89], v[66:67], v[84:85] op_sel:[1,1,0] op_sel_hi:[0,1,1] neg_hi:[1,0,0]
    v_pk_fma_f32 v[86:87], v[90:91], v[66:67], v[86:87] op_sel:[1,1,0] op_sel_hi:[0,1,1] neg_hi:[1,0,0]
    ds_write_addtid_b32 v62 offset:53664
    ds_write_addtid_b32 v63 offset:55728
    v_pk_mul_f32 v[88:89], v[84:85], v[66:67] op_sel:[0,0] op_sel_hi:[1,0]
    v_pk_mul_f32 v[90:91], v[86:87], v[66:67] op_sel:[0,0] op_sel_hi:[1,0]
    v_cvt_pk_bf16_f32 v60, v84, v85
    v_cvt_pk_bf16_f32 v61, v86, v87
    v_pk_fma_f32 v[88:89], v[84:85], v[66:67], v[88:89] op_sel:[1,1,0] op_sel_hi:[0,1,1] neg_hi:[1,0,0]
    v_pk_fma_f32 v[90:91], v[86:87], v[66:67], v[90:91] op_sel:[1,1,0] op_sel_hi:[0,1,1] neg_hi:[1,0,0]
    ds_write_addtid_b32 v60 offset:57792
    ds_write_addtid_b32 v61 offset:59856
    v_cvt_pk_bf16_f32 v62, v88, v89
    v_cvt_pk_bf16_f32 v63, v90, v91
    ds_write_addtid_b32 v62 offset:61920
    ds_write_addtid_b32 v63 offset:63984
    ds_read_b128 v[96:99], v40 offset:0
    ds_read_b128 v[128:131], v39 offset:0
    ds_read_b128 v[100:103], v40 offset:32
    ds_read_b128 v[132:135], v39 offset:32
    ds_read_b128 v[104:107], v40 offset:64
    ds_read_b128 v[136:139], v39 offset:64
    ds_read_b128 v[108:111], v40 offset:96
    ds_read_b128 v[140:143], v39 offset:96
    ds_read_b128 v[112:115], v40 offset:128
    ds_read_b128 v[144:147], v39 offset:128
    ds_read_b128 v[116:119], v40 offset:160
    ds_read_b128 v[148:151], v39 offset:160
    ds_read_b128 v[120:123], v40 offset:192
    ds_read_b128 v[152:155], v39 offset:192
    ds_read_b128 v[124:127], v40 offset:224
    ds_read_b128 v[156:159], v39 offset:224
    s_add_u32 s41, s56, 2
    s_and_b32 s41, s41, 3
    s_mul_i32 s41, s41, 896
    v_add_u32 v64, s41, v253
    global_load_dwordx2 v[12:13], v64, s[12:13]
    v_and_b32 v52, 0xffff0000, v2
    v_and_b32 v53, 0xffff0000, v3
    v_and_b32 v54, 0xffff0000, v4
    v_and_b32 v55, 0xffff0000, v5
    v_and_b32 v56, 0xffff0000, v6
    v_and_b32 v57, 0xffff0000, v7
    v_mul_f32 v52, v51, v52
    v_mul_f32 v53, v51, v53
    v_mul_f32 v54, v51, v54
    v_mul_f32 v55, v51, v55
    v_mul_f32 v52, 1069066811, v52
    v_mul_f32 v53, 0.15915494, v53
    v_pk_mul_f32 v[84:85], v[56:57], v[54:55] op_sel:[0,0] op_sel_hi:[1,0]
    v_pk_fma_f32 v[84:85], v[56:57], v[54:55], v[84:85] op_sel:[1,1,0] op_sel_hi:[0,1,1] neg_lo:[1,0,0]
    v_xor_b32 v85, 0x80000000, v85
    v_exp_f32 v54, v52
    v_fract_f32 v55, v53
    v_cos_f32 v64, v55
    v_sin_f32 v65, v55
    s_nop 0
    v_mul_f32 v64, v54, v64
    v_mul_f32 v65, v54, v65
    v_mul_f32 v54, 0x41000000, v52
    v_mul_f32 v55, 0x41000000, v53
    v_exp_f32 v54, v54
    v_fract_f32 v55, v55
    v_cos_f32 v74, v55
    v_sin_f32 v75, v55
    s_nop 0
    v_mul_f32 v74, v54, v74
    v_mul_f32 v75, v54, v75
    v_mul_f32 v54, 0x43800000, v52
    v_mul_f32 v55, 0x43800000, v53
    v_exp_f32 v54, v54
    v_fract_f32 v55, v55
    v_cos_f32 v76, v55
    v_sin_f32 v77, v55
    s_nop 0
    v_mul_f32 v76, v54, v76
    v_mul_f32 v77, v54, v77
    s_waitcnt lgkmcnt(0)
    s_mul_i32 s41, s38, 5984
    s_add_u32 m0, s41, 8192
    v_pk_mul_f32 v[66:67], v[64:65], v[64:65] op_sel:[0,0] op_sel_hi:[1,0]
    v_pk_mul_f32 v[78:79], v[76:77], v[76:77] op_sel:[0,0] op_sel_hi:[1,0]
    v_cvt_pk_bf16_f32 v60, v64, v65
    v_cvt_pk_bf16_f32 v61, v76, v77
    v_pk_fma_f32 v[66:67], v[64:65], v[64:65], v[66:67] op_sel:[1,1,0] op_sel_hi:[0,1,1] neg_lo:[1,0,0]
    v_pk_fma_f32 v[78:79], v[76:77], v[76:77], v[78:79] op_sel:[1,1,0] op_sel_hi:[0,1,1] neg_lo:[1,0,0]
    ds_write_addtid_b32 v60 offset:58128
    ds_write_addtid_b32 v61 offset:60032
    v_mfma_f32_32x32x16_bf16 v[160:175], v[96:99], v[128:131], 0
    v_pk_mul_f32 v[68:69], v[66:67], v[64:65] op_sel:[0,0] op_sel_hi:[1,0]
    v_pk_mul_f32 v[70:71], v[66:67], v[66:67] op_sel:[0,0] op_sel_hi:[1,0]
    v_cvt_pk_bf16_f32 v62, v66, v67
    v_cvt_pk_bf16_f32 v63, v78, v79
    v_pk_fma_f32 v[68:69], v[66:67], v[64:65], v[68:69] op_sel:[1,1,0] op_sel_hi:[0,1,1] neg_lo:[1,0,0]
    v_pk_fma_f32 v[70:71], v[66:67], v[66:67], v[70:71] op_sel:[1,1,0] op_sel_hi:[0,1,1] neg_lo:[1,0,0]
    ds_write_addtid_b32 v62 offset:58400
    ds_write_addtid_b32 v63 offset:60576
    v_mfma_f32_32x32x16_bf16 v[160:175], v[100:103], v[132:135], v[160:175]
    v_pk_mul_f32 v[80:81], v[78:79], v[76:77] op_sel:[0,0] op_sel_hi:[1,0]
    v_pk_mul_f32 v[82:83], v[78:79], v[78:79] op_sel:[0,0] op_sel_hi:[1,0]
    v_cvt_pk_bf16_f32 v60, v68, v69
    v_cvt_pk_bf16_f32 v61, v70, v71
    v_pk_fma_f32 v[80:81], v[78:79], v[76:77], v[80:81] op_sel:[1,1,0] op_sel_hi:[0,1,1] neg_lo:[1,0,0]
    v_pk_fma_f32 v[82:83], v[78:79], v[78:79], v[82:83] op_sel:[1,1,0] op_sel_hi:[0,1,1] neg_lo:[1,0,0]
    ds_write_addtid_b32 v60 offset:58672
    ds_write_addtid_b32 v61 offset:58944
    v_mfma_f32_32x32x16_bf16 v[160:175], v[104:107], v[136:139], v[160:175]
    v_pk_mul_f32 v[88:89], v[70:71], v[64:65] op_sel:[0,0] op_sel_hi:[1,0]
    v_pk_mul_f32 v[72:73], v[68:69], v[68:69] op_sel:[0,0] op_sel_hi:[1,0]
    v_cvt_pk_bf16_f32 v62, v80, v81
    v_cvt_pk_bf16_f32 v63, v82, v83
    v_pk_fma_f32 v[88:89], v[70:71], v[64:65], v[88:89] op_sel:[1,1,0] op_sel_hi:[0,1,1] neg_lo:[1,0,0]
    v_pk_fma_f32 v[72:73], v[68:69], v[68:69], v[72:73] op_sel:[1,1,0] op_sel_hi:[0,1,1] neg_lo:[1,0,0]
    ds_write_addtid_b32 v62 offset:60848
    ds_write_addtid_b32 v63 offset:62208
    v_mfma_f32_32x32x16_bf16 v[160:175], v[108:111], v[140:143], v[160:175]
    v_pk_mul_f32 v[90:91], v[70:71], v[68:69] op_sel:[0,0] op_sel_hi:[1,0]
    v_pk_mul_f32 v[86:87], v[76:77], v[66:67] op_sel:[0,0] op_sel_hi:[1,0]
    v_cvt_pk_bf16_f32 v60, v88, v89
    v_cvt_pk_bf16_f32 v61, v72, v73
    v_pk_fma_f32 v[90:91], v[70:71], v[68:69], v[90:91] op_sel:[1,1,0] op_sel_hi:[0,1,1] neg_lo:[1,0,0]
    v_pk_fma_f32 v[86:87], v[76:77], v[66:67], v[86:87] op_sel:[1,1,0] op_sel_hi:[0,1,1] neg_lo:[1,0,0]
    ds_write_addtid_b32 v60 offset:59216
    ds_write_addtid_b32 v61 offset:59488
    v_mfma_f32_32x32x16_bf16 v[160:175], v[112:115], v[144:147], v[160:175]
    v_pk_mul_f32 v[88:89], v[76:77], v[70:71] op_sel:[0,0] op_sel_hi:[1,0]
    v_pk_mul_f32 v[68:69], v[76:77], v[72:73] op_sel:[0,0] op_sel_hi:[1,0]
    v_cvt_pk_bf16_f32 v62, v90, v91
    v_cvt_pk_bf16_f32 v63, v86, v87
    v_pk_fma_f32 v[88:89], v[76:77], v[70:71], v[88:89] op_sel:[1,1,0] op_sel_hi:[0,1,1] neg_lo:[1,0,0]
    v_pk_fma_f32 v[68:69], v[76:77], v[72:73], v[68:69] op_sel:[1,1,0] op_sel_hi:[0,1,1] neg_lo:[1,0,0]
    ds_write_addtid_b32 v62 offset:59760
    ds_write_addtid_b32 v63 offset:60304
    v_mfma_f32_32x32x16_bf16 v[160:175], v[116:119], v[148:151], v[160:175]
    v_pk_mul_f32 v[90:91], v[78:79], v[70:71] op_sel:[0,0] op_sel_hi:[1,0]
    v_pk_mul_f32 v[86:87], v[80:81], v[70:71] op_sel:[0,0] op_sel_hi:[1,0]
    v_cvt_pk_bf16_f32 v60, v88, v89
    v_cvt_pk_bf16_f32 v61, v68, v69
    v_pk_fma_f32 v[90:91], v[78:79], v[70:71], v[90:91] op_sel:[1,1,0] op_sel_hi:[0,1,1] neg_lo:[1,0,0]
    v_pk_fma_f32 v[86:87], v[80:81], v[70:71], v[86:87] op_sel:[1,1,0] op_sel_hi:[0,1,1] neg_lo:[1,0,0]
    ds_write_addtid_b32 v60 offset:61120
    ds_write_addtid_b32 v61 offset:61392
    v_mfma_f32_32x32x16_bf16 v[160:175], v[120:123], v[152:155], v[160:175]
    v_pk_mul_f32 v[88:89], v[82:83], v[76:77] op_sel:[0,0] op_sel_hi:[1,0]
    v_pk_mul_f32 v[68:69], v[82:83], v[78:79] op_sel:[0,0] op_sel_hi:[1,0]
    v_cvt_pk_bf16_f32 v62, v90, v91
    v_cvt_pk_bf16_f32 v63, v86, v87
    v_pk_fma_f32 v[88:89], v[82:83], v[76:77], v[88:89] op_sel:[1,1,0] op_sel_hi:[0,1,1] neg_lo:[1,0,0]
    v_pk_fma_f32 v[68:69], v[82:83], v[78:79], v[68:69] op_sel:[1,1,0] op_sel_hi:[0,1,1] neg_lo:[1,0,0]
    ds_write_addtid_b32 v62 offset:61664
    ds_write_addtid_b32 v63 offset:61936
    v_mfma_f32_32x32x16_bf16 v[160:175], v[124:127], v[156:159], v[160:175]
    v_pk_mul_f32 v[90:91], v[82:83], v[80:81] op_sel:[0,0] op_sel_hi:[1,0]
    v_pk_mul_f32 v[70:71], v[82:83], v[82:83] op_sel:[0,0] op_sel_hi:[1,0]
    v_cvt_pk_bf16_f32 v60, v88, v89
    v_cvt_pk_bf16_f32 v61, v68, v69
    v_pk_fma_f32 v[90:91], v[82:83], v[80:81], v[90:91] op_sel:[1,1,0] op_sel_hi:[0,1,1] neg_lo:[1,0,0]
    v_pk_fma_f32 v[70:71], v[82:83], v[82:83], v[70:71] op_sel:[1,1,0] op_sel_hi:[0,1,1] neg_lo:[1,0,0]
    ds_write_addtid_b32 v60 offset:63296
    ds_write_addtid_b32 v61 offset:62480
    v_pk_mul_f32 v[86:87], v[84:85], v[74:75] op_sel:[0,0] op_sel_hi:[1,0]
    v_pk_mul_f32 v[66:67], v[74:75], v[74:75] op_sel:[0,0] op_sel_hi:[1,0]
    v_cvt_pk_bf16_f32 v62, v90, v91
    v_cvt_pk_bf16_f32 v63, v70, v71
    v_pk_fma_f32 v[86:87], v[84:85], v[74:75], v[86:87] op_sel:[1,1,0] op_sel_hi:[0,1,1] neg_hi:[1,0,0]
    v_pk_fma_f32 v[66:67], v[74:75], v[74:75], v[66:67] op_sel:[1,1,0] op_sel_hi:[0,1,1] neg_lo:[1,0,0]
    ds_write_addtid_b32 v62 offset:63568
    ds_write_addtid_b32 v63 offset:62752
    s_lshl_b32 m0, s38, 8
    s_add_u32 s41, s56, 3
    s_and_b32 s41, s41, 3
    s_mul_i32 s41, s41, 896
    v_add_u32 v64, s41, v253
    global_load_dwordx2 v[14:15], v64, s[12:13]
    v_pk_mul_f32 v[88:89], v[84:85], v[66:67] op_sel:[0,0] op_sel_hi:[1,0]
    v_pk_mul_f32 v[90:91], v[86:87], v[66:67] op_sel:[0,0] op_sel_hi:[1,0]
    v_cvt_pk_bf16_f32 v60, v84, v85
    v_cvt_pk_bf16_f32 v61, v86, v87
    v_pk_fma_f32 v[88:89], v[84:85], v[66:67], v[88:89] op_sel:[1,1,0] op_sel_hi:[0,1,1] neg_hi:[1,0,0]
    v_pk_fma_f32 v[90:91], v[86:87], v[66:67], v[90:91] op_sel:[1,1,0] op_sel_hi:[0,1,1] neg_hi:[1,0,0]
    ds_write_addtid_b32 v60 offset:0
    ds_write_addtid_b32 v61 offset:2064
    v_pk_mul_f32 v[84:85], v[88:89], v[66:67] op_sel:[0,0] op_sel_hi:[1,0]
    v_pk_mul_f32 v[86:87], v[90:91], v[66:67] op_sel:[0,0] op_sel_hi:[1,0]
    v_cvt_pk_bf16_f32 v62, v88, v89
    v_cvt_pk_bf16_f32 v63, v90, v91
    v_pk_fma_f32 v[84:85], v[88:89], v[66:67], v[84:85] op_sel:[1,1,0] op_sel_hi:[0,1,1] neg_hi:[1,0,0]
    v_pk_fma_f32 v[86:87], v[90:91], v[66:67], v[86:87] op_sel:[1,1,0] op_sel_hi:[0,1,1] neg_hi:[1,0,0]
    ds_write_addtid_b32 v62 offset:4128
    ds_write_addtid_b32 v63 offset:6192
    v_pk_mul_f32 v[88:89], v[84:85], v[66:67] op_sel:[0,0] op_sel_hi:[1,0]
    v_pk_mul_f32 v[90:91], v[86:87], v[66:67] op_sel:[0,0] op_sel_hi:[1,0]
    v_cvt_pk_bf16_f32 v60, v84, v85
    v_cvt_pk_bf16_f32 v61, v86, v87
    v_pk_fma_f32 v[88:89], v[84:85], v[66:67], v[88:89] op_sel:[1,1,0] op_sel_hi:[0,1,1] neg_hi:[1,0,0]
    v_pk_fma_f32 v[90:91], v[86:87], v[66:67], v[90:91] op_sel:[1,1,0] op_sel_hi:[0,1,1] neg_hi:[1,0,0]
    ds_write_addtid_b32 v60 offset:8256
    ds_write_addtid_b32 v61 offset:10320
    v_pk_mul_f32 v[84:85], v[88:89], v[66:67] op_sel:[0,0] op_sel_hi:[1,0]
    v_pk_mul_f32 v[86:87], v[90:91], v[66:67] op_sel:[0,0] op_sel_hi:[1,0]
    v_cvt_pk_bf16_f32 v62, v88, v89
    v_cvt_pk_bf16_f32 v63, v90, v91
    v_pk_fma_f32 v[84:85], v[88:89], v[66:67], v[84:85] op_sel:[1,1,0] op_sel_hi:[0,1,1] neg_hi:[1,0,0]
    v_pk_fma_f32 v[86:87], v[90:91], v[66:67], v[86:87] op_sel:[1,1,0] op_sel_hi:[0,1,1] neg_hi:[1,0,0]
    ds_write_addtid_b32 v62 offset:12384
    ds_write_addtid_b32 v63 offset:14448
    v_pk_mul_f32 v[88:89], v[84:85], v[66:67] op_sel:[0,0] op_sel_hi:[1,0]
    v_pk_mul_f32 v[90:91], v[86:87], v[66:67] op_sel:[0,0] op_sel_hi:[1,0]
    v_cvt_pk_bf16_f32 v60, v84, v85
    v_cvt_pk_bf16_f32 v61, v86, v87
    v_pk_fma_f32 v[88:89], v[84:85], v[66:67], v[88:89] op_sel:[1,1,0] op_sel_hi:[0,1,1] neg_hi:[1,0,0]
    v_pk_fma_f32 v[90:91], v[86:87], v[66:67], v[90:91] op_sel:[1,1,0] op_sel_hi:[0,1,1] neg_hi:[1,0,0]
    ds_write_addtid_b32 v60 offset:16512
    ds_write_addtid_b32 v61 offset:18576
    v_pk_mul_f32 v[84:85], v[88:89], v[66:67] op_sel:[0,0] op_sel_hi:[1,0]
    v_pk_mul_f32 v[86:87], v[90:91], v[66:67] op_sel:[0,0] op_sel_hi:[1,0]
    v_cvt_pk_bf16_f32 v62, v88, v89
    v_cvt_pk_bf16_f32 v63, v90, v91
    v_pk_fma_f32 v[84:85], v[88:89], v[66:67], v[84:85] op_sel:[1,1,0] op_sel_hi:[0,1,1] neg_hi:[1,0,0]
    v_pk_fma_f32 v[86:87], v[90:91], v[66:67], v[86:87] op_sel:[1,1,0] op_sel_hi:[0,1,1] neg_hi:[1,0,0]
    ds_write_addtid_b32 v62 offset:20640
    ds_write_addtid_b32 v63 offset:22704
    v_pk_mul_f32 v[88:89], v[84:85], v[66:67] op_sel:[0,0] op_sel_hi:[1,0]
    v_pk_mul_f32 v[90:91], v[86:87], v[66:67] op_sel:[0,0] op_sel_hi:[1,0]
    v_cvt_pk_bf16_f32 v60, v84, v85
    v_cvt_pk_bf16_f32 v61, v86, v87
    v_pk_fma_f32 v[88:89], v[84:85], v[66:67], v[88:89] op_sel:[1,1,0] op_sel_hi:[0,1,1] neg_hi:[1,0,0]
    v_pk_fma_f32 v[90:91], v[86:87], v[66:67], v[90:91] op_sel:[1,1,0] op_sel_hi:[0,1,1] neg_hi:[1,0,0]
    ds_write_addtid_b32 v60 offset:24768
    ds_write_addtid_b32 v61 offset:26832
    v_pk_mul_f32 v[84:85], v[88:89], v[66:67] op_sel:[0,0] op_sel_hi:[1,0]
    v_pk_mul_f32 v[86:87], v[90:91], v[66:67] op_sel:[0,0] op_sel_hi:[1,0]
    v_cvt_pk_bf16_f32 v62, v88, v89
    v_cvt_pk_bf16_f32 v63, v90, v91
    v_pk_fma_f32 v[84:85], v[88:89], v[66:67], v[84:85] op_sel:[1,1,0] op_sel_hi:[0,1,1] neg_hi:[1,0,0]
    v_pk_fma_f32 v[86:87], v[90:91], v[66:67], v[86:87] op_sel:[1,1,0] op_sel_hi:[0,1,1] neg_hi:[1,0,0]
    ds_write_addtid_b32 v62 offset:28896
    ds_write_addtid_b32 v63 offset:30960
    v_pk_mul_f32 v[88:89], v[84:85], v[66:67] op_sel:[0,0] op_sel_hi:[1,0]
    v_pk_mul_f32 v[90:91], v[86:87], v[66:67] op_sel:[0,0] op_sel_hi:[1,0]
    v_cvt_pk_bf16_f32 v60, v84, v85
    v_cvt_pk_bf16_f32 v61, v86, v87
    v_pk_fma_f32 v[88:89], v[84:85], v[66:67], v[88:89] op_sel:[1,1,0] op_sel_hi:[0,1,1] neg_hi:[1,0,0]
    v_pk_fma_f32 v[90:91], v[86:87], v[66:67], v[90:91] op_sel:[1,1,0] op_sel_hi:[0,1,1] neg_hi:[1,0,0]
    ds_write_addtid_b32 v60 offset:33024
    ds_write_addtid_b32 v61 offset:35088
    v_pk_mul_f32 v[84:85], v[88:89], v[66:67] op_sel:[0,0] op_sel_hi:[1,0]
    v_pk_mul_f32 v[86:87], v[90:91], v[66:67] op_sel:[0,0] op_sel_hi:[1,0]
    v_cvt_pk_bf16_f32 v62, v88, v89
    v_cvt_pk_bf16_f32 v63, v90, v91
    v_pk_fma_f32 v[84:85], v[88:89], v[66:67], v[84:85] op_sel:[1,1,0] op_sel_hi:[0,1,1] neg_hi:[1,0,0]
    v_pk_fma_f32 v[86:87], v[90:91], v[66:67], v[86:87] op_sel:[1,1,0] op_sel_hi:[0,1,1] neg_hi:[1,0,0]
    ds_write_addtid_b32 v62 offset:37152
    ds_write_addtid_b32 v63 offset:39216
    v_pk_mul_f32 v[88:89], v[84:85], v[66:67] op_sel:[0,0] op_sel_hi:[1,0]
    v_pk_mul_f32 v[90:91], v[86:87], v[66:67] op_sel:[0,0] op_sel_hi:[1,0]
    v_cvt_pk_bf16_f32 v60, v84, v85
    v_cvt_pk_bf16_f32 v61, v86, v87
    v_pk_fma_f32 v[88:89], v[84:85], v[66:67], v[88:89] op_sel:[1,1,0] op_sel_hi:[0,1,1] neg_hi:[1,0,0]
    v_pk_fma_f32 v[90:91], v[86:87], v[66:67], v[90:91] op_sel:[1,1,0] op_sel_hi:[0,1,1] neg_hi:[1,0,0]
    ds_write_addtid_b32 v60 offset:41280
    ds_write_addtid_b32 v61 offset:43344
    v_pk_mul_f32 v[84:85], v[88:89], v[66:67] op_sel:[0,0] op_sel_hi:[1,0]
    v_pk_mul_f32 v[86:87], v[90:91], v[66:67] op_sel:[0,0] op_sel_hi:[1,0]
    v_cvt_pk_bf16_f32 v62, v88, v89
    v_cvt_pk_bf16_f32 v63, v90, v91
    v_pk_fma_f32 v[84:85], v[88:89], v[66:67], v[84:85] op_sel:[1,1,0] op_sel_hi:[0,1,1] neg_hi:[1,0,0]
    v_pk_fma_f32 v[86:87], v[90:91], v[66:67], v[86:87] op_sel:[1,1,0] op_sel_hi:[0,1,1] neg_hi:[1,0,0]
    ds_write_addtid_b32 v62 offset:45408
    ds_write_addtid_b32 v63 offset:47472
    v_pk_mul_f32 v[88:89], v[84:85], v[66:67] op_sel:[0,0] op_sel_hi:[1,0]
    v_pk_mul_f32 v[90:91], v[86:87], v[66:67] op_sel:[0,0] op_sel_hi:[1,0]
    v_cvt_pk_bf16_f32 v60, v84, v85
    v_cvt_pk_bf16_f32 v61, v86, v87
    v_pk_fma_f32 v[88:89], v[84:85], v[66:67], v[88:89] op_sel:[1,1,0] op_sel_hi:[0,1,1] neg_hi:[1,0,0]
    v_pk_fma_f32 v[90:91], v[86:87], v[66:67], v[90:91] op_sel:[1,1,0] op_sel_hi:[0,1,1] neg_hi:[1,0,0]
    ds_write_addtid_b32 v60 offset:49536
    ds_write_addtid_b32 v61 offset:51600
    v_pk_mul_f32 v[84:85], v[88:89], v[66:67] op_sel:[0,0] op_sel_hi:[1,0]
    v_pk_mul_f32 v[86:87], v[90:91], v[66:67] op_sel:[0,0] op_sel_hi:[1,0]
    v_cvt_pk_bf16_f32 v62, v88, v89
    v_cvt_pk_bf16_f32 v63, v90, v91
    v_pk_fma_f32 v[84:85], v[88:89], v[66:67], v[84:85] op_sel:[1,1,0] op_sel_hi:[0,1,1] neg_hi:[1,0,0]
    v_pk_fma_f32 v[86:87], v[90:91], v[66:67], v[86:87] op_sel:[1,1,0] op_sel_hi:[0,1,1] neg_hi:[1,0,0]
    ds_write_addtid_b32 v62 offset:53664
    ds_write_addtid_b32 v63 offset:55728
    v_pk_mul_f32 v[88:89], v[84:85], v[66:67] op_sel:[0,0] op_sel_hi:[1,0]
    v_pk_mul_f32 v[90:91], v[86:87], v[66:67] op_sel:[0,0] op_sel_hi:[1,0]
    v_cvt_pk_bf16_f32 v60, v84, v85
    v_cvt_pk_bf16_f32 v61, v86, v87
    v_pk_fma_f32 v[88:89], v[84:85], v[66:67], v[88:89] op_sel:[1,1,0] op_sel_hi:[0,1,1] neg_hi:[1,0,0]
    v_pk_fma_f32 v[90:91], v[86:87], v[66:67], v[90:91] op_sel:[1,1,0] op_sel_hi:[0,1,1] neg_hi:[1,0,0]
    ds_write_addtid_b32 v60 offset:57792
    ds_write_addtid_b32 v61 offset:59856
    v_cvt_pk_bf16_f32 v62, v88, v89
    v_cvt_pk_bf16_f32 v63, v90, v91
    ds_write_addtid_b32 v62 offset:61920
    ds_write_addtid_b32 v63 offset:63984
    ds_read_b128 v[96:99], v40 offset:0
    ds_read_b128 v[128:131], v39 offset:0
    ds_read_b128 v[100:103], v40 offset:32
    ds_read_b128 v[132:135], v39 offset:32
    ds_read_b128 v[104:107], v40 offset:64
    ds_read_b128 v[136:139], v39 offset:64
    ds_read_b128 v[108:111], v40 offset:96
    ds_read_b128 v[140:143], v39 offset:96
    ds_read_b128 v[112:115], v40 offset:128
    ds_read_b128 v[144:147], v39 offset:128
    ds_read_b128 v[116:119], v40 offset:160
    ds_read_b128 v[148:151], v39 offset:160
    ds_read_b128 v[120:123], v40 offset:192
    ds_read_b128 v[152:155], v39 offset:192
    ds_read_b128 v[124:127], v40 offset:224
    ds_read_b128 v[156:159], v39 offset:224
    s_waitcnt lgkmcnt(0)
    v_mfma_f32_32x32x16_bf16 v[160:175], v[96:99], v[128:131], v[160:175]
    v_mfma_f32_32x32x16_bf16 v[160:175], v[100:103], v[132:135], v[160:175]
    v_mfma_f32_32x32x16_bf16 v[160:175], v[104:107], v[136:139], v[160:175]
    v_mfma_f32_32x32x16_bf16 v[160:175], v[108:111], v[140:143], v[160:175]
    v_mfma_f32_32x32x16_bf16 v[160:175], v[112:115], v[144:147], v[160:175]
    v_mfma_f32_32x32x16_bf16 v[160:175], v[116:119], v[148:151], v[160:175]
    v_mfma_f32_32x32x16_bf16 v[160:175], v[120:123], v[152:155], v[160:175]
    v_mfma_f32_32x32x16_bf16 v[160:175], v[124:127], v[156:159], v[160:175]
    s_mov_b32 s41, 0x05040100
    s_mov_b32 s42, 0x07060302
    v_lshlrev_b32 v62, 3, v254
    v_add_u32 v62, 118016, v62
    s_waitcnt vmcnt(0)
    s_cmp_eq_u32 s56, 1
    s_cbranch_scc1 B_u_8
    s_cmp_eq_u32 s56, 2
    s_cbranch_scc1 B_u_9
    s_cmp_eq_u32 s56, 3
    s_cbranch_scc1 B_u_10
    v_perm_b32 v52, v10, v8, s41
    v_perm_b32 v53, v14, v12, s41
    ds_write_b64 v62, v[52:53] offset:0
    v_perm_b32 v54, v10, v8, s42
    v_perm_b32 v55, v14, v12, s42
    ds_write_b64 v62, v[54:55] offset:4608
    v_perm_b32 v56, v11, v9, s41
    v_perm_b32 v57, v15, v13, s41
    ds_write_b64 v62, v[56:57] offset:9216
    v_perm_b32 v58, v11, v9, s42
    v_perm_b32 v59, v15, v13, s42
    ds_write_b64 v62, v[58:59] offset:13824
    s_branch B_u_11
B_u_8:
    v_perm_b32 v52, v8, v14, s41
    v_perm_b32 v53, v12, v10, s41
    ds_write_b64 v62, v[52:53] offset:0
    v_perm_b32 v54, v8, v14, s42
    v_perm_b32 v55, v12, v10, s42
    ds_write_b64 v62, v[54:55] offset:4608
    v_perm_b32 v56, v9, v15, s41
    v_perm_b32 v57, v13, v11, s41
    ds_write_b64 v62, v[56:57] offset:9216
    v_perm_b32 v58, v9, v15, s42
    v_perm_b32 v59, v13, v11, s42
    ds_write_b64 v62, v[58:59] offset:13824
    s_branch B_u_11
B_u_9:
    v_perm_b32 v52, v14, v12, s41
    v_perm_b32 v53, v10, v8, s41
    ds_write_b64 v62, v[52:53] offset:0
    v_perm_b32 v54, v14, v12, s42
    v_perm_b32 v55, v10, v8, s42
    ds_write_b64 v62, v[54:55] offset:4608
    v_perm_b32 v56, v15, v13, s41
    v_perm_b32 v57, v11, v9, s41
    ds_write_b64 v62, v[56:57] offset:9216
    v_perm_b32 v58, v15, v13, s42
    v_perm_b32 v59, v11, v9, s42
    ds_write_b64 v62, v[58:59] offset:13824
    s_branch B_u_11
B_u_10:
    v_perm_b32 v52, v12, v10, s41
    v_perm_b32 v53, v8, v14, s41
    ds_write_b64 v62, v[52:53] offset:0
    v_perm_b32 v54, v12, v10, s42
    v_perm_b32 v55, v8, v14, s42
    ds_write_b64 v62, v[54:55] offset:4608
    v_perm_b32 v56, v13, v11, s41
    v_perm_b32 v57, v9, v15, s41
    ds_write_b64 v62, v[56:57] offset:9216
    v_perm_b32 v58, v13, v11, s42
    v_perm_b32 v59, v9, v15, s42
    ds_write_b64 v62, v[58:59] offset:13824
B_u_11:
    s_nop 7
    s_nop 7
    s_nop 3
    s_mul_i32 s41, s38, 5984
    s_add_u32 s41, s41, 66048
    v_lshl_add_u32 v52, v1, 4, s41
    s_xor_b32 s42, s38, 1
    s_mul_i32 s41, s42, 5984
    s_add_u32 s41, s41, 66048
    v_lshl_add_u32 v53, v1, 4, s41
    s_cmp_eq_u32 s40, 1
    s_cbranch_scc1 B_kx1_12
    ds_write_b128 v52, v[166:169]
    ds_write_b32 v52, v170 offset:1024
    s_branch B_kxj_13
B_kx1_12:
    ds_write_b128 v52, v[160:163]
    ds_write_b64 v52, v[164:165] offset:1024
B_kxj_13:
    s_waitcnt lgkmcnt(0)
    s_barrier
    ds_read_b128 v[64:67], v53
    ds_read_b64 v[68:69], v53 offset:1024
    s_cmp_eq_u32 s40, 1
    s_cbranch_scc1 B_ky1_14
    s_waitcnt lgkmcnt(0)
    v_pk_add_f32 v[64:65], v[64:65], v[160:161]
    v_pk_add_f32 v[66:67], v[66:67], v[162:163]
    v_pk_add_f32 v[68:69], v[68:69], v[164:165]
    ds_write_b128 v41, v[64:67]
    ds_write_b64 v42, v[68:69] offset:1024
    s_branch B_kyj_15
B_ky1_14:
    s_waitcnt lgkmcnt(0)
    v_pk_add_f32 v[64:65], v[64:65], v[166:167]
    v_pk_add_f32 v[66:67], v[66:67], v[168:169]
    v_add_f32 v68, v68, v170
    ds_write_b32 v43, v64 offset:1536
    ds_write_b32 v43, v65 offset:1792
    ds_write_b32 v44, v66 offset:2048
    ds_write_b32 v44, v67 offset:2304
    ds_write_b32 v45, v68
B_kyj_15:
    s_waitcnt lgkmcnt(0)
    s_barrier
    ds_read_b32 v64, v16
    ds_read_b32 v65, v17
    ds_read_b32 v66, v18
    ds_read_b32 v67, v19
    ds_read_b32 v68, v20
    ds_read_b32 v69, v21
    ds_read_b32 v70, v22
    ds_read_b32 v71, v23
    ds_read_b32 v72, v24
    ds_read_b32 v73, v25
    ds_read_b32 v74, v26
    ds_read_b32 v75, v27
    ds_read_b32 v76, v28
    ds_read_b32 v77, v29
    ds_read_b32 v78, v30
    ds_read_b32 v79, v31
    ds_read_b32 v80, v32
    ds_read_b32 v81, v33
    ds_read_b32 v82, v34
    ds_read_b32 v83, v35
    ds_read_b32 v84, v36
    ds_read_b32 v85, v37
    v_and_b32 v52, 1, v1
    v_bfe_u32 v53, v1, 1, 4
    v_mul_u32_u24 v53, 4160, v53
    v_lshl_add_u32 v53, v52, 4, v53
    v_mov_b32 v60, 0
    v_mov_b32 v61, 0
    v_mov_b32 v62, 0
    v_mov_b32 v63, 0
    ds_write_b128 v53, v[60:63] offset:4096
    s_waitcnt lgkmcnt(12)
    v_cvt_pk_bf16_f32 v96, v64, v65
    v_cvt_pk_bf16_f32 v97, v66, v67
    v_cvt_pk_bf16_f32 v98, v68, v69
    v_cvt_pk_bf16_f32 v99, v70, v71
    ds_write_b128 v38, v[96:99] offset:0
    v_cvt_pk_bf16_f32 v100, v67, v68
    v_cvt_pk_bf16_f32 v101, v69, v70
    v_cvt_pk_bf16_f32 v102, v71, v72
    v_cvt_pk_bf16_f32 v103, v73, v74
    ds_write_b128 v38, v[100:103] offset:4160
    v_cvt_pk_bf16_f32 v104, v66, v67
    v_cvt_pk_bf16_f32 v105, v68, v69
    v_cvt_pk_bf16_f32 v106, v70, v71
    v_cvt_pk_bf16_f32 v107, v72, v73
    ds_write_b128 v38, v[104:107] offset:8320
    v_cvt_pk_bf16_f32 v108, v65, v66
    v_cvt_pk_bf16_f32 v109, v67, v68
    v_cvt_pk_bf16_f32 v110, v69, v70
    v_cvt_pk_bf16_f32 v111, v71, v72
    ds_write_b128 v38, v[108:111] offset:12480
    s_waitcnt lgkmcnt(5)
    v_cvt_pk_bf16_f32 v112, v75, v76
    v_cvt_pk_bf16_f32 v113, v77, v78
    v_cvt_pk_bf16_f32 v114, v79, v80
    v_cvt_pk_bf16_f32 v115, v81, v82
    ds_write_b128 v38, v[112:115] offset:2048
    v_cvt_pk_bf16_f32 v116, v78, v79
    v_cvt_pk_bf16_f32 v117, v80, v81
    v_cvt_pk_bf16_f32 v118, v82, v83
    v_cvt_pk_bf16_f32 v119, v84, v85
    ds_write_b128 v38, v[116:119] offset:6208
    v_cvt_pk_bf16_f32 v120, v77, v78
    v_cvt_pk_bf16_f32 v121, v79, v80
    v_cvt_pk_bf16_f32 v122, v81, v82
    v_cvt_pk_bf16_f32 v123, v83, v84
    ds_write_b128 v38, v[120:123] offset:10368
    v_cvt_pk_bf16_f32 v124, v76, v77
    v_cvt_pk_bf16_f32 v125, v78, v79
    v_cvt_pk_bf16_f32 v126, v80, v81
    v_cvt_pk_bf16_f32 v127, v82, v83
    ds_write_b128 v38, v[124:127] offset:14528
    s_waitcnt lgkmcnt(0)
    s_barrier
    ds_read_b128 v[96:99], v47 offset:192
    ds_read_b128 v[100:103], v47 offset:704
    ds_read_b128 v[104:107], v47 offset:1216
    ds_read_b128 v[108:111], v47 offset:1728
    ds_read_b128 v[112:115], v47 offset:2240
    ds_read_b128 v[116:119], v47 offset:2752
    ds_read_b128 v[120:123], v47 offset:3264
    ds_read_b128 v[124:127], v47 offset:3776
    ds_read_b64 v[64:65], v46 offset:3776
    ds_read_b64 v[66:67], v46 offset:3784
    ds_read_b64 v[68:69], v46 offset:3264
    ds_read_b64 v[70:71], v46 offset:3272
    ds_read_b64 v[72:73], v46 offset:2752
    ds_read_b64 v[74:75], v46 offset:2760
    ds_read_b64 v[76:77], v46 offset:2240
    ds_read_b64 v[78:79], v46 offset:2248
    ds_read_b64 v[80:81], v46 offset:1728
    ds_read_b64 v[82:83], v46 offset:1736
    ds_read_b64 v[84:85], v46 offset:1216
    ds_read_b64 v[86:87], v46 offset:1224
    ds_read_b64 v[88:89], v46 offset:704
    ds_read_b64 v[90:91], v46 offset:712
    ds_read_b64 v[92:93], v46 offset:192
    ds_read_b64 v[94:95], v46 offset:200
    s_waitcnt lgkmcnt(0)
    v_mfma_f32_16x16x32_bf16 v[220:223], v[64:67], v[124:127], 0
    ds_read_b128 v[160:163], v47 offset:128
    v_mfma_f32_16x16x32_bf16 v[216:219], v[64:67], v[120:123], 0
    ds_read_b128 v[164:167], v47 offset:640
    v_mfma_f32_16x16x32_bf16 v[212:215], v[64:67], v[116:119], 0
    ds_read_b128 v[168:171], v47 offset:1152
    v_mfma_f32_16x16x32_bf16 v[208:211], v[64:67], v[112:115], 0
    ds_read_b128 v[172:175], v47 offset:1664
    v_mfma_f32_16x16x32_bf16 v[204:207], v[64:67], v[108:111], 0
    ds_read_b128 v[176:179], v47 offset:2176
    v_mfma_f32_16x16x32_bf16 v[200:203], v[64:67], v[104:107], 0
    ds_read_b128 v[180:183], v47 offset:2688
    v_mfma_f32_16x16x32_bf16 v[196:199], v[64:67], v[100:103], 0
    ds_read_b128 v[184:187], v47 offset:3200
    v_mfma_f32_16x16x32_bf16 v[192:195], v[64:67], v[96:99], 0
    ds_read_b128 v[188:191], v47 offset:3712
    v_mfma_f32_16x16x32_bf16 v[220:223], v[68:71], v[120:123], v[220:223]
    ds_read_b64 v[128:129], v46 offset:3712
    v_mfma_f32_16x16x32_bf16 v[216:219], v[68:71], v[116:119], v[216:219]
    ds_read_b64 v[130:131], v46 offset:3720
    v_mfma_f32_16x16x32_bf16 v[212:215], v[68:71], v[112:115], v[212:215]
    ds_read_b64 v[132:133], v46 offset:3200
    v_mfma_f32_16x16x32_bf16 v[208:211], v[68:71], v[108:111], v[208:211]
    ds_read_b64 v[134:135], v46 offset:3208
    v_mfma_f32_16x16x32_bf16 v[204:207], v[68:71], v[104:107], v[204:207]
    ds_read_b64 v[136:137], v46 offset:2688
    v_mfma_f32_16x16x32_bf16 v[200:203], v[68:71], v[100:103], v[200:203]
    ds_read_b64 v[138:139], v46 offset:2696
    v_mfma_f32_16x16x32_bf16 v[196:199], v[68:71], v[96:99], v[196:199]
    ds_read_b64 v[140:141], v46 offset:2176
    v_mfma_f32_16x16x32_bf16 v[220:223], v[72:75], v[116:119], v[220:223]
    ds_read_b64 v[142:143], v46 offset:2184
    v_mfma_f32_16x16x32_bf16 v[216:219], v[72:75], v[112:115], v[216:219]
    ds_read_b64 v[144:145], v46 offset:1664
    v_mfma_f32_16x16x32_bf16 v[212:215], v[72:75], v[108:111], v[212:215]
    ds_read_b64 v[146:147], v46 offset:1672
    v_mfma_f32_16x16x32_bf16 v[208:211], v[72:75], v[104:107], v[208:211]
    ds_read_b64 v[148:149], v46 offset:1152
    v_mfma_f32_16x16x32_bf16 v[204:207], v[72:75], v[100:103], v[204:207]
    ds_read_b64 v[150:151], v46 offset:1160
    v_mfma_f32_16x16x32_bf16 v[200:203], v[72:75], v[96:99], v[200:203]
    ds_read_b64 v[152:153], v46 offset:640
    v_mfma_f32_16x16x32_bf16 v[220:223], v[76:79], v[112:115], v[220:223]
    ds_read_b64 v[154:155], v46 offset:648
    v_mfma_f32_16x16x32_bf16 v[216:219], v[76:79], v[108:111], v[216:219]
    ds_read_b64 v[156:157], v46 offset:128
    v_mfma_f32_16x16x32_bf16 v[212:215], v[76:79], v[104:107], v[212:215]
    ds_read_b64 v[158:159], v46 offset:136
    v_mfma_f32_16x16x32_bf16 v[208:211], v[76:79], v[100:103], v[208:211]
    v_mfma_f32_16x16x32_bf16 v[204:207], v[76:79], v[96:99], v[204:207]
    v_mfma_f32_16x16x32_bf16 v[220:223], v[80:83], v[108:111], v[220:223]
    v_mfma_f32_16x16x32_bf16 v[216:219], v[80:83], v[104:107], v[216:219]
    v_mfma_f32_16x16x32_bf16 v[212:215], v[80:83], v[100:103], v[212:215]
    v_mfma_f32_16x16x32_bf16 v[208:211], v[80:83], v[96:99], v[208:211]
    v_mfma_f32_16x16x32_bf16 v[220:223], v[84:87], v[104:107], v[220:223]
    v_mfma_f32_16x16x32_bf16 v[216:219], v[84:87], v[100:103], v[216:219]
    v_mfma_f32_16x16x32_bf16 v[212:215], v[84:87], v[96:99], v[212:215]
    v_mfma_f32_16x16x32_bf16 v[220:223], v[88:91], v[100:103], v[220:223]
    v_mfma_f32_16x16x32_bf16 v[216:219], v[88:91], v[96:99], v[216:219]
    v_mfma_f32_16x16x32_bf16 v[220:223], v[92:95], v[96:99], v[220:223]
    s_waitcnt lgkmcnt(0)
    v_mfma_f32_16x16x32_bf16 v[220:223], v[128:131], v[188:191], v[220:223]
    ds_read_b128 v[96:99], v47 offset:64
    v_mfma_f32_16x16x32_bf16 v[216:219], v[128:131], v[184:187], v[216:219]
    ds_read_b128 v[100:103], v47 offset:576
    v_mfma_f32_16x16x32_bf16 v[212:215], v[128:131], v[180:183], v[212:215]
    ds_read_b128 v[104:107], v47 offset:1088
    v_mfma_f32_16x16x32_bf16 v[208:211], v[128:131], v[176:179], v[208:211]
    ds_read_b128 v[108:111], v47 offset:1600
    v_mfma_f32_16x16x32_bf16 v[204:207], v[128:131], v[172:175], v[204:207]
    ds_read_b128 v[112:115], v47 offset:2112
    v_mfma_f32_16x16x32_bf16 v[200:203], v[128:131], v[168:171], v[200:203]
    ds_read_b128 v[116:119], v47 offset:2624
    v_mfma_f32_16x16x32_bf16 v[196:199], v[128:131], v[164:167], v[196:199]
    ds_read_b128 v[120:123], v47 offset:3136
    v_mfma_f32_16x16x32_bf16 v[192:195], v[128:131], v[160:163], v[192:195]
    ds_read_b128 v[124:127], v47 offset:3648
    v_mfma_f32_16x16x32_bf16 v[220:223], v[132:135], v[184:187], v[220:223]
    ds_read_b64 v[64:65], v46 offset:3648
    v_mfma_f32_16x16x32_bf16 v[216:219], v[132:135], v[180:183], v[216:219]
    ds_read_b64 v[66:67], v46 offset:3656
    v_mfma_f32_16x16x32_bf16 v[212:215], v[132:135], v[176:179], v[212:215]
    ds_read_b64 v[68:69], v46 offset:3136
    v_mfma_f32_16x16x32_bf16 v[208:211], v[132:135], v[172:175], v[208:211]
    ds_read_b64 v[70:71], v46 offset:3144
    v_mfma_f32_16x16x32_bf16 v[204:207], v[132:135], v[168:171], v[204:207]
    ds_read_b64 v[72:73], v46 offset:2624
    v_mfma_f32_16x16x32_bf16 v[200:203], v[132:135], v[164:167], v[200:203]
    ds_read_b64 v[74:75], v46 offset:2632
    v_mfma_f32_16x16x32_bf16 v[196:199], v[132:135], v[160:163], v[196:199]
    ds_read_b64 v[76:77], v46 offset:2112
    v_mfma_f32_16x16x32_bf16 v[220:223], v[136:139], v[180:183], v[220:223]
    ds_read_b64 v[78:79], v46 offset:2120
    v_mfma_f32_16x16x32_bf16 v[216:219], v[136:139], v[176:179], v[216:219]
    ds_read_b64 v[80:81], v46 offset:1600
    v_mfma_f32_16x16x32_bf16 v[212:215], v[136:139], v[172:175], v[212:215]
    ds_read_b64 v[82:83], v46 offset:1608
    v_mfma_f32_16x16x32_bf16 v[208:211], v[136:139], v[168:171], v[208:211]
    ds_read_b64 v[84:85], v46 offset:1088
    v_mfma_f32_16x16x32_bf16 v[204:207], v[136:139], v[164:167], v[204:207]
    ds_read_b64 v[86:87], v46 offset:1096
    v_mfma_f32_16x16x32_bf16 v[200:203], v[136:139], v[160:163], v[200:203]
    ds_read_b64 v[88:89], v46 offset:576
    v_mfma_f32_16x16x32_bf16 v[220:223], v[140:143], v[176:179], v[220:223]
    ds_read_b64 v[90:91], v46 offset:584
    v_mfma_f32_16x16x32_bf16 v[216:219], v[140:143], v[172:175], v[216:219]
    ds_read_b64 v[92:93], v46 offset:64
    v_mfma_f32_16x16x32_bf16 v[212:215], v[140:143], v[168:171], v[212:215]
    ds_read_b64 v[94:95], v46 offset:72
    v_mfma_f32_16x16x32_bf16 v[208:211], v[140:143], v[164:167], v[208:211]
    v_mfma_f32_16x16x32_bf16 v[204:207], v[140:143], v[160:163], v[204:207]
    v_mfma_f32_16x16x32_bf16 v[220:223], v[144:147], v[172:175], v[220:223]
    v_mfma_f32_16x16x32_bf16 v[216:219], v[144:147], v[168:171], v[216:219]
    v_mfma_f32_16x16x32_bf16 v[212:215], v[144:147], v[164:167], v[212:215]
    v_mfma_f32_16x16x32_bf16 v[208:211], v[144:147], v[160:163], v[208:211]
    v_mfma_f32_16x16x32_bf16 v[220:223], v[148:151], v[168:171], v[220:223]
    v_mfma_f32_16x16x32_bf16 v[216:219], v[148:151], v[164:167], v[216:219]
    v_mfma_f32_16x16x32_bf16 v[212:215], v[148:151], v[160:163], v[212:215]
    v_mfma_f32_16x16x32_bf16 v[220:223], v[152:155], v[164:167], v[220:223]
    v_mfma_f32_16x16x32_bf16 v[216:219], v[152:155], v[160:163], v[216:219]
    v_mfma_f32_16x16x32_bf16 v[220:223], v[156:159], v[160:163], v[220:223]
    s_waitcnt lgkmcnt(0)
    v_mfma_f32_16x16x32_bf16 v[220:223], v[64:67], v[124:127], v[220:223]
    ds_read_b128 v[160:163], v47 offset:0
    v_mfma_f32_16x16x32_bf16 v[216:219], v[64:67], v[120:123], v[216:219]
    ds_read_b128 v[164:167], v47 offset:512
    v_mfma_f32_16x16x32_bf16 v[212:215], v[64:67], v[116:119], v[212:215]
    ds_read_b128 v[168:171], v47 offset:1024
    v_mfma_f32_16x16x32_bf16 v[208:211], v[64:67], v[112:115], v[208:211]
    ds_read_b128 v[172:175], v47 offset:1536
    v_mfma_f32_16x16x32_bf16 v[204:207], v[64:67], v[108:111], v[204:207]
    ds_read_b128 v[176:179], v47 offset:2048
    v_mfma_f32_16x16x32_bf16 v[200:203], v[64:67], v[104:107], v[200:203]
    ds_read_b128 v[180:183], v47 offset:2560
    v_mfma_f32_16x16x32_bf16 v[196:199], v[64:67], v[100:103], v[196:199]
    ds_read_b128 v[184:187], v47 offset:3072
    v_mfma_f32_16x16x32_bf16 v[192:195], v[64:67], v[96:99], v[192:195]
    ds_read_b128 v[188:191], v47 offset:3584
    v_mfma_f32_16x16x32_bf16 v[220:223], v[68:71], v[120:123], v[220:223]
    ds_read_b64 v[128:129], v46 offset:3584
    v_mfma_f32_16x16x32_bf16 v[216:219], v[68:71], v[116:119], v[216:219]
    ds_read_b64 v[130:131], v46 offset:3592
    v_mfma_f32_16x16x32_bf16 v[212:215], v[68:71], v[112:115], v[212:215]
    ds_read_b64 v[132:133], v46 offset:3072
    v_mfma_f32_16x16x32_bf16 v[208:211], v[68:71], v[108:111], v[208:211]
    ds_read_b64 v[134:135], v46 offset:3080
    v_mfma_f32_16x16x32_bf16 v[204:207], v[68:71], v[104:107], v[204:207]
    ds_read_b64 v[136:137], v46 offset:2560
    v_mfma_f32_16x16x32_bf16 v[200:203], v[68:71], v[100:103], v[200:203]
    ds_read_b64 v[138:139], v46 offset:2568
    v_mfma_f32_16x16x32_bf16 v[196:199], v[68:71], v[96:99], v[196:199]
    ds_read_b64 v[140:141], v46 offset:2048
    v_mfma_f32_16x16x32_bf16 v[220:223], v[72:75], v[116:119], v[220:223]
    ds_read_b64 v[142:143], v46 offset:2056
    v_mfma_f32_16x16x32_bf16 v[216:219], v[72:75], v[112:115], v[216:219]
    ds_read_b64 v[144:145], v46 offset:1536
    v_mfma_f32_16x16x32_bf16 v[212:215], v[72:75], v[108:111], v[212:215]
    ds_read_b64 v[146:147], v46 offset:1544
    v_mfma_f32_16x16x32_bf16 v[208:211], v[72:75], v[104:107], v[208:211]
    ds_read_b64 v[148:149], v46 offset:1024
    v_mfma_f32_16x16x32_bf16 v[204:207], v[72:75], v[100:103], v[204:207]
    ds_read_b64 v[150:151], v46 offset:1032
    v_mfma_f32_16x16x32_bf16 v[200:203], v[72:75], v[96:99], v[200:203]
    ds_read_b64 v[152:153], v46 offset:512
    v_mfma_f32_16x16x32_bf16 v[220:223], v[76:79], v[112:115], v[220:223]
    ds_read_b64 v[154:155], v46 offset:520
    v_mfma_f32_16x16x32_bf16 v[216:219], v[76:79], v[108:111], v[216:219]
    ds_read_b64 v[156:157], v46 offset:0
    v_mfma_f32_16x16x32_bf16 v[212:215], v[76:79], v[104:107], v[212:215]
    ds_read_b64 v[158:159], v46 offset:8
    v_mfma_f32_16x16x32_bf16 v[208:211], v[76:79], v[100:103], v[208:211]
    ds_read_b128 v[240:243], v252 offset:0
    v_mfma_f32_16x16x32_bf16 v[204:207], v[76:79], v[96:99], v[204:207]
    ds_read_b128 v[244:247], v252 offset:1024
    v_mfma_f32_16x16x32_bf16 v[220:223], v[80:83], v[108:111], v[220:223]
    v_mfma_f32_16x16x32_bf16 v[216:219], v[80:83], v[104:107], v[216:219]
    v_mfma_f32_16x16x32_bf16 v[212:215], v[80:83], v[100:103], v[212:215]
    v_mfma_f32_16x16x32_bf16 v[208:211], v[80:83], v[96:99], v[208:211]
    v_mfma_f32_16x16x32_bf16 v[220:223], v[84:87], v[104:107], v[220:223]
    v_mfma_f32_16x16x32_bf16 v[216:219], v[84:87], v[100:103], v[216:219]
    v_mfma_f32_16x16x32_bf16 v[212:215], v[84:87], v[96:99], v[212:215]
    v_mfma_f32_16x16x32_bf16 v[220:223], v[88:91], v[100:103], v[220:223]
    v_mfma_f32_16x16x32_bf16 v[216:219], v[88:91], v[96:99], v[216:219]
    v_mfma_f32_16x16x32_bf16 v[220:223], v[92:95], v[96:99], v[220:223]
    s_waitcnt lgkmcnt(0)
    v_mfma_f32_16x16x32_bf16 v[220:223], v[128:131], v[188:191], v[220:223]
    v_lshlrev_b32 v248, 16, v240
    v_and_b32 v249, 0xffff0000, v240
    v_mfma_f32_16x16x32_bf16 v[216:219], v[128:131], v[184:187], v[216:219]
    v_mul_f32 v248, s54, v248
    v_mul_f32 v249, s55, v249
    v_mfma_f32_16x16x32_bf16 v[212:215], v[128:131], v[180:183], v[212:215]
    v_cvt_pk_bf16_f32 v248, v248, v249
    v_mfma_f32_16x16x32_bf16 v[208:211], v[128:131], v[176:179], v[208:211]
    v_lshlrev_b32 v224, 16, v248
    v_and_b32 v225, 0xffff0000, v248
    v_mfma_f32_16x16x32_bf16 v[204:207], v[128:131], v[172:175], v[204:207]
    v_lshlrev_b32 v250, 16, v241
    v_and_b32 v251, 0xffff0000, v241
    v_mfma_f32_16x16x32_bf16 v[200:203], v[128:131], v[168:171], v[200:203]
    v_mul_f32 v250, s54, v250
    v_mul_f32 v251, s55, v251
    v_mfma_f32_16x16x32_bf16 v[196:199], v[128:131], v[164:167], v[196:199]
    v_cvt_pk_bf16_f32 v250, v250, v251
    v_mfma_f32_16x16x32_bf16 v[192:195], v[128:131], v[160:163], v[192:195]
    v_lshlrev_b32 v226, 16, v250
    v_and_b32 v227, 0xffff0000, v250
    v_mfma_f32_16x16x32_bf16 v[220:223], v[132:135], v[184:187], v[220:223]
    v_lshlrev_b32 v248, 16, v242
    v_and_b32 v249, 0xffff0000, v242
    v_mfma_f32_16x16x32_bf16 v[216:219], v[132:135], v[180:183], v[216:219]
    v_mul_f32 v248, s54, v248
    v_mul_f32 v249, s55, v249
    v_mfma_f32_16x16x32_bf16 v[212:215], v[132:135], v[176:179], v[212:215]
    v_cvt_pk_bf16_f32 v248, v248, v249
    v_mfma_f32_16x16x32_bf16 v[208:211], v[132:135], v[172:175], v[208:211]
    v_lshlrev_b32 v228, 16, v248
    v_and_b32 v229, 0xffff0000, v248
    v_mfma_f32_16x16x32_bf16 v[204:207], v[132:135], v[168:171], v[204:207]
    v_lshlrev_b32 v250, 16, v243
    v_and_b32 v251, 0xffff0000, v243
    v_mfma_f32_16x16x32_bf16 v[200:203], v[132:135], v[164:167], v[200:203]
    v_mul_f32 v250, s54, v250
    v_mul_f32 v251, s55, v251
    v_mfma_f32_16x16x32_bf16 v[196:199], v[132:135], v[160:163], v[196:199]
    v_cvt_pk_bf16_f32 v250, v250, v251
    v_mfma_f32_16x16x32_bf16 v[220:223], v[136:139], v[180:183], v[220:223]
    v_lshlrev_b32 v230, 16, v250
    v_and_b32 v231, 0xffff0000, v250
    v_mfma_f32_16x16x32_bf16 v[216:219], v[136:139], v[176:179], v[216:219]
    v_lshlrev_b32 v248, 16, v244
    v_and_b32 v249, 0xffff0000, v244
    v_mfma_f32_16x16x32_bf16 v[212:215], v[136:139], v[172:175], v[212:215]
    v_mul_f32 v248, s54, v248
    v_mul_f32 v249, s55, v249
    v_mfma_f32_16x16x32_bf16 v[208:211], v[136:139], v[168:171], v[208:211]
    v_cvt_pk_bf16_f32 v248, v248, v249
    v_mfma_f32_16x16x32_bf16 v[204:207], v[136:139], v[164:167], v[204:207]
    v_lshlrev_b32 v232, 16, v248
    v_and_b32 v233, 0xffff0000, v248
    v_mfma_f32_16x16x32_bf16 v[200:203], v[136:139], v[160:163], v[200:203]
    v_lshlrev_b32 v250, 16, v245
    v_and_b32 v251, 0xffff0000, v245
    v_mfma_f32_16x16x32_bf16 v[220:223], v[140:143], v[176:179], v[220:223]
    v_mul_f32 v250, s54, v250
    v_mul_f32 v251, s55, v251
    v_mfma_f32_16x16x32_bf16 v[216:219], v[140:143], v[172:175], v[216:219]
    v_cvt_pk_bf16_f32 v250, v250, v251
    v_mfma_f32_16x16x32_bf16 v[212:215], v[140:143], v[168:171], v[212:215]
    v_lshlrev_b32 v234, 16, v250
    v_and_b32 v235, 0xffff0000, v250
    v_mfma_f32_16x16x32_bf16 v[208:211], v[140:143], v[164:167], v[208:211]
    v_lshlrev_b32 v248, 16, v246
    v_and_b32 v249, 0xffff0000, v246
    v_mfma_f32_16x16x32_bf16 v[204:207], v[140:143], v[160:163], v[204:207]
    v_mul_f32 v248, s54, v248
    v_mul_f32 v249, s55, v249
    v_mfma_f32_16x16x32_bf16 v[220:223], v[144:147], v[172:175], v[220:223]
    v_cvt_pk_bf16_f32 v248, v248, v249
    v_mfma_f32_16x16x32_bf16 v[216:219], v[144:147], v[168:171], v[216:219]
    v_lshlrev_b32 v236, 16, v248
    v_and_b32 v237, 0xffff0000, v248
    v_mfma_f32_16x16x32_bf16 v[212:215], v[144:147], v[164:167], v[212:215]
    v_lshlrev_b32 v250, 16, v247
    v_and_b32 v251, 0xffff0000, v247
    v_mfma_f32_16x16x32_bf16 v[208:211], v[144:147], v[160:163], v[208:211]
    v_mul_f32 v250, s54, v250
    v_mul_f32 v251, s55, v251
    v_mfma_f32_16x16x32_bf16 v[220:223], v[148:151], v[168:171], v[220:223]
    v_cvt_pk_bf16_f32 v250, v250, v251
    v_mfma_f32_16x16x32_bf16 v[216:219], v[148:151], v[164:167], v[216:219]
    v_lshlrev_b32 v238, 16, v250
    v_and_b32 v239, 0xffff0000, v250
    v_mfma_f32_16x16x32_bf16 v[212:215], v[148:151], v[160:163], v[212:215]
    v_mfma_f32_16x16x32_bf16 v[220:223], v[152:155], v[164:167], v[220:223]
    v_mfma_f32_16x16x32_bf16 v[216:219], v[152:155], v[160:163], v[216:219]
    v_mfma_f32_16x16x32_bf16 v[220:223], v[156:159], v[160:163], v[220:223]
    s_nop 7
    s_nop 1
    s_cmp_eq_u32 s40, 1
    s_cbranch_scc1 B_h1_16
    ds_write_b128 v48, v[208:211] offset:0
    ds_write_b128 v48, v[212:215] offset:1024
    ds_write_b128 v48, v[216:219] offset:2048
    ds_write_b128 v48, v[220:223] offset:3072
    s_branch B_hx_17
B_h1_16:
    ds_write_b128 v48, v[192:195] offset:0
    ds_write_b128 v48, v[196:199] offset:1024
    ds_write_b128 v48, v[200:203] offset:2048
    ds_write_b128 v48, v[204:207] offset:3072
    v_mov_b32 v192, v208
    v_mov_b32 v193, v209
    v_mov_b32 v194, v210
    v_mov_b32 v195, v211
    v_mov_b32 v196, v212
    v_mov_b32 v197, v213
    v_mov_b32 v198, v214
    v_mov_b32 v199, v215
    v_mov_b32 v200, v216
    v_mov_b32 v201, v217
    v_mov_b32 v202, v218
    v_mov_b32 v203, v219
    v_mov_b32 v204, v220
    v_mov_b32 v205, v221
    v_mov_b32 v206, v222
    v_mov_b32 v207, v223
B_hx_17:
    s_waitcnt lgkmcnt(0)
    s_barrier
    ds_read_b128 v[64:67], v49 offset:0
    ds_read_b128 v[68:71], v49 offset:1024
    ds_read_b128 v[72:75], v49 offset:2048
    ds_read_b128 v[76:79], v49 offset:3072
    s_waitcnt lgkmcnt(2)
    v_add_f32 v64, v64, v192
    v_add_f32 v65, v65, v193
    v_add_f32 v66, v66, v194
    v_add_f32 v67, v67, v195
    v_add_f32 v68, v68, v196
    v_add_f32 v69, v69, v197
    v_add_f32 v70, v70, v198
    v_add_f32 v71, v71, v199
    v_cvt_pk_bf16_f32 v96, v64, v65
    v_cvt_pk_bf16_f32 v97, v66, v67
    v_cvt_pk_bf16_f32 v98, v68, v69
    v_cvt_pk_bf16_f32 v99, v70, v71
    s_nop 1
    v_permlane16_swap_b32 v96, v98
    v_permlane16_swap_b32 v97, v99
    s_nop 1
    v_lshlrev_b32 v248, 16, v96
    v_and_b32 v249, 0xffff0000, v96
    v_pk_add_f32 v[248:249], v[248:249], v[224:225]
    v_cvt_pk_bf16_f32 v96, v248, v249
    v_lshlrev_b32 v250, 16, v97
    v_and_b32 v251, 0xffff0000, v97
    v_pk_add_f32 v[250:251], v[250:251], v[226:227]
    v_cvt_pk_bf16_f32 v97, v250, v251
    v_lshlrev_b32 v248, 16, v98
    v_and_b32 v249, 0xffff0000, v98
    v_pk_add_f32 v[248:249], v[248:249], v[228:229]
    v_cvt_pk_bf16_f32 v98, v248, v249
    v_lshlrev_b32 v250, 16, v99
    v_and_b32 v251, 0xffff0000, v99
    v_pk_add_f32 v[250:251], v[250:251], v[230:231]
    v_cvt_pk_bf16_f32 v99, v250, v251
    buffer_store_dwordx4 v[96:99], v50, s[44:47], s50 offen
    s_add_u32 s50, s50, 458752
    s_waitcnt lgkmcnt(0)
    v_add_f32 v72, v72, v200
    v_add_f32 v73, v73, v201
    v_add_f32 v74, v74, v202
    v_add_f32 v75, v75, v203
    v_add_f32 v76, v76, v204
    v_add_f32 v77, v77, v205
    v_add_f32 v78, v78, v206
    v_add_f32 v79, v79, v207
    v_cvt_pk_bf16_f32 v100, v72, v73
    v_cvt_pk_bf16_f32 v101, v74, v75
    v_cvt_pk_bf16_f32 v102, v76, v77
    v_cvt_pk_bf16_f32 v103, v78, v79
    s_nop 1
    v_permlane16_swap_b32 v100, v102
    v_permlane16_swap_b32 v101, v103
    s_nop 1
    v_lshlrev_b32 v248, 16, v100
    v_and_b32 v249, 0xffff0000, v100
    v_pk_add_f32 v[248:249], v[248:249], v[232:233]
    v_cvt_pk_bf16_f32 v100, v248, v249
    v_lshlrev_b32 v250, 16, v101
    v_and_b32 v251, 0xffff0000, v101
    v_pk_add_f32 v[250:251], v[250:251], v[234:235]
    v_cvt_pk_bf16_f32 v101, v250, v251
    v_lshlrev_b32 v248, 16, v102
    v_and_b32 v249, 0xffff0000, v102
    v_pk_add_f32 v[248:249], v[248:249], v[236:237]
    v_cvt_pk_bf16_f32 v102, v248, v249
    v_lshlrev_b32 v250, 16, v103
    v_and_b32 v251, 0xffff0000, v103
    v_pk_add_f32 v[250:251], v[250:251], v[238:239]
    v_cvt_pk_bf16_f32 v103, v250, v251
    buffer_store_dwordx4 v[100:103], v50, s[44:47], s50 offen
    s_endpgm
L1_W:
    s_sub_u32 s36, s2, 240
    v_lshrrev_b32 v5, 6, v0
    v_and_b32 v1, 63, v0
    s_nop 0
    v_readfirstlane_b32 s38, v5
    v_lshrrev_b32 v5, 5, v1
    v_and_b32 v6, 31, v1
    s_mul_i32 s41, s36, 25088
    s_lshl_b32 s42, s38, 7
    s_add_u32 s41, s41, s42
    v_mul_u32_u24 v2, 3584, v5
    v_lshl_add_u32 v2, v6, 1, v2
    v_add_u32 v2, s41, v2
    v_lshl_add_u32 v4, v6, 1, s41
    s_lshl_b32 s41, s38, 16
    s_lshl_b32 s42, s36, 11
    s_add_u32 s41, s41, s42
    s_add_u32 s41, s41, 6291456
    v_lshl_add_u32 v3, v1, 4, s41
    v_cmp_gt_u32 vcc, 32, v1
    s_cmp_ge_u32 s38, 7
    s_cbranch_scc1 W_end_18
    s_waitcnt lgkmcnt(0)
    s_mov_b32 s44, s10
    s_mov_b32 s45, s11
    s_mov_b32 s46, 401408
    s_mov_b32 s47, 0x00020000
    s_mov_b32 s48, s34
    s_mov_b32 s49, s35
    s_mov_b32 s50, 268435456
    s_mov_b32 s51, 0x00020000
    s_mov_b32 s41, 0
    buffer_load_ushort v16, v2, s[44:47], s41 offen offset:0
    s_mov_b32 s41, 896
    buffer_load_ushort v17, v2, s[44:47], s41 offen offset:0
    s_mov_b32 s41, 1792
    buffer_load_ushort v18, v2, s[44:47], s41 offen offset:0
    s_mov_b32 s41, 2688
    buffer_load_ushort v19, v2, s[44:47], s41 offen offset:0
    s_mov_b32 s41, 7168
    buffer_load_ushort v20, v2, s[44:47], s41 offen offset:0
    s_mov_b32 s41, 8064
    buffer_load_ushort v21, v2, s[44:47], s41 offen offset:0
    s_mov_b32 s41, 8960
    buffer_load_ushort v22, v2, s[44:47], s41 offen offset:0
    s_mov_b32 s41, 9856
    buffer_load_ushort v23, v2, s[44:47], s41 offen offset:0
    s_mov_b32 s41, 14336
    buffer_load_ushort v24, v2, s[44:47], s41 offen offset:0
    s_mov_b32 s41, 15232
    buffer_load_ushort v25, v2, s[44:47], s41 offen offset:0
    s_mov_b32 s41, 16128
    buffer_load_ushort v26, v2, s[44:47], s41 offen offset:0
    s_mov_b32 s41, 17024
    buffer_load_ushort v27, v2, s[44:47], s41 offen offset:0
    s_mov_b32 s41, 21504
    buffer_load_ushort v28, v4, s[44:47], s41 offen offset:0
    s_mov_b32 s41, 22400
    buffer_load_ushort v29, v4, s[44:47], s41 offen offset:0
    s_mov_b32 s41, 23296
    buffer_load_ushort v30, v4, s[44:47], s41 offen offset:0
    s_mov_b32 s41, 24192
    buffer_load_ushort v31, v4, s[44:47], s41 offen offset:0
    s_mov_b32 s41, 0
    buffer_load_ushort v32, v2, s[44:47], s41 offen offset:64
    s_mov_b32 s41, 896
    buffer_load_ushort v33, v2, s[44:47], s41 offen offset:64
    s_mov_b32 s41, 1792
    buffer_load_ushort v34, v2, s[44:47], s41 offen offset:64
    s_mov_b32 s41, 2688
    buffer_load_ushort v35, v2, s[44:47], s41 offen offset:64
    s_mov_b32 s41, 7168
    buffer_load_ushort v36, v2, s[44:47], s41 offen offset:64
    s_mov_b32 s41, 8064
    buffer_load_ushort v37, v2, s[44:47], s41 offen offset:64
    s_mov_b32 s41, 8960
    buffer_load_ushort v38, v2, s[44:47], s41 offen offset:64
    s_mov_b32 s41, 9856
    buffer_load_ushort v39, v2, s[44:47], s41 offen offset:64
    s_mov_b32 s41, 14336
    buffer_load_ushort v40, v2, s[44:47], s41 offen offset:64
    s_mov_b32 s41, 15232
    buffer_load_ushort v41, v2, s[44:47], s41 offen offset:64
    s_mov_b32 s41, 16128
    buffer_load_ushort v42, v2, s[44:47], s41 offen offset:64
    s_mov_b32 s41, 17024
    buffer_load_ushort v43, v2, s[44:47], s41 offen offset:64
    s_mov_b32 s41, 21504
    buffer_load_ushort v44, v4, s[44:47], s41 offen offset:64
    s_mov_b32 s41, 22400
    buffer_load_ushort v45, v4, s[44:47], s41 offen offset:64
    s_mov_b32 s41, 23296
    buffer_load_ushort v46, v4, s[44:47], s41 offen offset:64
    s_mov_b32 s41, 24192
    buffer_load_ushort v47, v4, s[44:47], s41 offen offset:64
    s_waitcnt vmcnt(24)
    v_lshl_or_b32 v64, v17, 16, v16
    v_lshl_or_b32 v65, v19, 16, v18
    v_lshl_or_b32 v66, v21, 16, v20
    v_lshl_or_b32 v67, v23, 16, v22
    s_waitcnt vmcnt(16)
    v_lshl_or_b32 v68, v25, 16, v24
    v_lshl_or_b32 v69, v27, 16, v26
    v_lshl_or_b32 v70, v29, 16, v28
    v_lshl_or_b32 v71, v31, 16, v30
    v_cndmask_b32 v70, 0, v70, vcc
    v_cndmask_b32 v71, 0, v71, vcc
    s_waitcnt vmcnt(8)
    v_lshl_or_b32 v72, v33, 16, v32
    v_lshl_or_b32 v73, v35, 16, v34
    v_lshl_or_b32 v74, v37, 16, v36
    v_lshl_or_b32 v75, v39, 16, v38
    s_waitcnt vmcnt(0)
    v_lshl_or_b32 v76, v41, 16, v40
    v_lshl_or_b32 v77, v43, 16, v42
    v_lshl_or_b32 v78, v45, 16, v44
    v_lshl_or_b32 v79, v47, 16, v46
    v_cndmask_b32 v78, 0, v78, vcc
    v_cndmask_b32 v79, 0, v79, vcc
    s_mov_b32 s41, 0
    buffer_store_dwordx4 v[64:67], v3, s[48:51], s41 offen
    s_mov_b32 s41, 1024
    buffer_store_dwordx4 v[68:71], v3, s[48:51], s41 offen
    s_mov_b32 s41, 32768
    buffer_store_dwordx4 v[72:75], v3, s[48:51], s41 offen
    s_mov_b32 s41, 33792
    buffer_store_dwordx4 v[76:79], v3, s[48:51], s41 offen
W_end_18:
    s_endpgm
L1_END:
    s_endpgm
.text
.globl l2_kernel
.p2align 8
.type l2_kernel,@function
l2_kernel:
    s_load_dwordx16 s[4:19], s[0:1], 0
    s_load_dwordx16 s[20:35], s[0:1], 64
    s_cmp_ge_u32 s2, 256
    s_cbranch_scc1 L2_END
    s_and_b32 s41, s2, 7
    s_lshl_b32 s41, s41, 3
    s_bfe_u32 s42, s2, 0x30003
    s_add_u32 s36, s41, s42
    s_lshr_b32 s37, s2, 6
    v_lshrrev_b32 v12, 6, v0
    v_and_b32 v1, 63, v0
    s_nop 0
    v_readfirstlane_b32 s38, v12
    v_lshlrev_b32 v13, 4, v1
    s_lshl_b32 s41, s36, 16
    s_lshl_b32 s42, s38, 14
    s_add_u32 s41, s41, s42
    s_add_u32 s41, s41, 1048576
    v_add_u32 v2, s41, v13
    v_add_u32 v3, s42, v13
    s_lshl_b32 s39, s37, 2
    s_add_u32 s39, s39, s38
    s_lshl_b32 s41, s39, 15
    s_add_u32 s41, s41, 6291456
    v_add_u32 v4, s41, v13
    s_waitcnt lgkmcnt(0)
    s_mov_b32 s44, s34
    s_mov_b32 s45, s35
    s_mov_b32 s46, 268435456
    s_mov_b32 s47, 0x00020000
    s_mov_b32 s41, 0
    buffer_load_dwordx4 v[128:131], v3, s[44:47], s41 offen
    buffer_load_dwordx4 v[64:67], v2, s[44:47], s41 offen
    s_mov_b32 s41, 1024
    buffer_load_dwordx4 v[132:135], v3, s[44:47], s41 offen
    buffer_load_dwordx4 v[68:71], v2, s[44:47], s41 offen
    s_mov_b32 s41, 2048
    buffer_load_dwordx4 v[136:139], v3, s[44:47], s41 offen
    buffer_load_dwordx4 v[72:75], v2, s[44:47], s41 offen
    s_mov_b32 s41, 3072
    buffer_load_dwordx4 v[140:143], v3, s[44:47], s41 offen
    buffer_load_dwordx4 v[76:79], v2, s[44:47], s41 offen
    s_mov_b32 s41, 4096
    buffer_load_dwordx4 v[144:147], v3, s[44:47], s41 offen
    buffer_load_dwordx4 v[80:83], v2, s[44:47], s41 offen
    s_mov_b32 s41, 5120
    buffer_load_dwordx4 v[148:151], v3, s[44:47], s41 offen
    buffer_load_dwordx4 v[84:87], v2, s[44:47], s41 offen
    s_mov_b32 s41, 6144
    buffer_load_dwordx4 v[152:155], v3, s[44:47], s41 offen
    buffer_load_dwordx4 v[88:91], v2, s[44:47], s41 offen
    s_mov_b32 s41, 7168
    buffer_load_dwordx4 v[156:159], v3, s[44:47], s41 offen
    buffer_load_dwordx4 v[92:95], v2, s[44:47], s41 offen
    s_mul_i32 s42, s36, 28672
    s_sub_u32 s41, s38, 2
    s_mul_i32 s41, s41, 14336
    s_add_u32 s42, s42, s41
    s_add_u32 s42, s42, 8388608
    v_lshl_add_u32 v8, v1, 4, s42
    v_lshlrev_b32 v13, 4, v1
    s_lshl_b32 s41, s38, 13
    v_add_u32 v5, s41, v13
    v_mov_b32 v6, v13
    v_and_b32 v12, 31, v1
    v_lshrrev_b32 v14, 5, v1
    s_lshl_b32 s41, s36, 5
    v_add_u32 v12, s41, v12
    v_mul_u32_u24 v7, 1792, v12
    v_lshl_add_u32 v7, v14, 4, v7
    s_mov_b32 s52, 0
    s_mov_b32 s53, -1
    s_mov_b32 s48, s30
    s_mov_b32 s49, s31
    s_mov_b32 s50, 3670016
    s_mov_b32 s51, 0x00020000
    s_cmp_ge_u32 s39, 14
    s_cbranch_scc1 L2_pB_1
    s_mov_b32 s41, 8192
    buffer_load_dwordx4 v[160:163], v3, s[44:47], s41 offen
    buffer_load_dwordx4 v[96:99], v2, s[44:47], s41 offen
    s_mov_b32 s41, 9216
    buffer_load_dwordx4 v[164:167], v3, s[44:47], s41 offen
    buffer_load_dwordx4 v[100:103], v2, s[44:47], s41 offen
    s_mov_b32 s41, 10240
    buffer_load_dwordx4 v[168:171], v3, s[44:47], s41 offen
    buffer_load_dwordx4 v[104:107], v2, s[44:47], s41 offen
    s_mov_b32 s41, 11264
    buffer_load_dwordx4 v[172:175], v3, s[44:47], s41 offen
    buffer_load_dwordx4 v[108:111], v2, s[44:47], s41 offen
    s_waitcnt vmcnt(16)
    v_mfma_f32_32x32x16_bf16 v[192:207], v[128:131], v[64:67], 0
    v_mfma_f32_32x32x16_bf16 v[192:207], v[132:135], v[68:71], v[192:207]
    v_mfma_f32_32x32x16_bf16 v[192:207], v[136:139], v[72:75], v[192:207]
    v_mfma_f32_32x32x16_bf16 v[192:207], v[140:143], v[76:79], v[192:207]
    s_mov_b32 s41, 12288
    buffer_load_dwordx4 v[176:179], v3, s[44:47], s41 offen
    buffer_load_dwordx4 v[112:115], v2, s[44:47], s41 offen
    s_mov_b32 s41, 13312
    buffer_load_dwordx4 v[180:183], v3, s[44:47], s41 offen
    buffer_load_dwordx4 v[116:119], v2, s[44:47], s41 offen
    s_mov_b32 s41, 14336
    buffer_load_dwordx4 v[184:187], v3, s[44:47], s41 offen
    buffer_load_dwordx4 v[120:123], v2, s[44:47], s41 offen
    s_mov_b32 s41, 15360
    buffer_load_dwordx4 v[188:191], v3, s[44:47], s41 offen
    buffer_load_dwordx4 v[124:127], v2, s[44:47], s41 offen
    s_waitcnt vmcnt(16)
    v_mfma_f32_32x32x16_bf16 v[208:223], v[144:147], v[80:83], 0
    v_mfma_f32_32x32x16_bf16 v[208:223], v[148:151], v[84:87], v[208:223]
    v_mfma_f32_32x32x16_bf16 v[208:223], v[152:155], v[88:91], v[208:223]
    v_mfma_f32_32x32x16_bf16 v[208:223], v[156:159], v[92:95], v[208:223]
    v_mov_b32 v12, v204
    v_mov_b32 v13, v204
    s_nop 1
    v_permlane32_swap_b32 v12, v13
    s_nop 1
    v_add_f32 v13, 0x358637bd, v13
    v_rcp_f32 v14, v13
    s_nop 0
    v_mov_b32 v15, v14
    v_pk_mul_f32 v[192:193], v[192:193], v[14:15]
    v_pk_mul_f32 v[194:195], v[194:195], v[14:15]
    v_pk_mul_f32 v[196:197], v[196:197], v[14:15]
    v_pk_mul_f32 v[198:199], v[198:199], v[14:15]
    v_pk_mul_f32 v[200:201], v[200:201], v[14:15]
    v_pk_mul_f32 v[202:203], v[202:203], v[14:15]
    v_pk_mul_f32 v[204:205], v[204:205], v[14:15]
    v_pk_mul_f32 v[206:207], v[206:207], v[14:15]
    v_cvt_pk_bf16_f32 v16, v192, v193
    v_cvt_pk_bf16_f32 v17, v194, v195
    v_cvt_pk_bf16_f32 v18, v196, v197
    v_cvt_pk_bf16_f32 v19, v198, v199
    v_cvt_pk_bf16_f32 v20, v200, v201
    v_cvt_pk_bf16_f32 v21, v202, v203
    v_cvt_pk_bf16_f32 v22, v204, v205
    v_cvt_pk_bf16_f32 v23, v206, v207
    v_cndmask_b32 v22, v22, 0, s[52:53]
    v_cndmask_b32 v23, v23, 0, s[52:53]
    ds_write_b128 v5, v[16:19] offset:0
    ds_write_b128 v5, v[20:23] offset:1024
    s_mov_b32 s41, 0
    buffer_load_dwordx4 a[0:3], v4, s[44:47], s41 offen
    s_mov_b32 s41, 1024
    buffer_load_dwordx4 a[4:7], v4, s[44:47], s41 offen
    s_mov_b32 s41, 2048
    buffer_load_dwordx4 a[8:11], v4, s[44:47], s41 offen
    s_mov_b32 s41, 3072
    buffer_load_dwordx4 a[12:15], v4, s[44:47], s41 offen
    s_mov_b32 s41, 4096
    buffer_load_dwordx4 a[16:19], v4, s[44:47], s41 offen
    s_mov_b32 s41, 5120
    buffer_load_dwordx4 a[20:23], v4, s[44:47], s41 offen
    s_mov_b32 s41, 6144
    buffer_load_dwordx4 a[24:27], v4, s[44:47], s41 offen
    s_mov_b32 s41, 7168
    buffer_load_dwordx4 a[28:31], v4, s[44:47], s41 offen
    s_waitcnt vmcnt(16)
    v_mfma_f32_32x32x16_bf16 v[224:239], v[160:163], v[96:99], 0
    v_mfma_f32_32x32x16_bf16 v[224:239], v[164:167], v[100:103], v[224:239]
    v_mfma_f32_32x32x16_bf16 v[224:239], v[168:171], v[104:107], v[224:239]
    v_mfma_f32_32x32x16_bf16 v[224:239], v[172:175], v[108:111], v[224:239]
    v_mov_b32 v12, v220
    v_mov_b32 v13, v220
    s_nop 1
    v_permlane32_swap_b32 v12, v13
    s_nop 1
    v_add_f32 v13, 0x358637bd, v13
    v_rcp_f32 v14, v13
    s_nop 0
    v_mov_b32 v15, v14
    v_pk_mul_f32 v[208:209], v[208:209], v[14:15]
    v_pk_mul_f32 v[210:211], v[210:211], v[14:15]
    v_pk_mul_f32 v[212:213], v[212:213], v[14:15]
    v_pk_mul_f32 v[214:215], v[214:215], v[14:15]
    v_pk_mul_f32 v[216:217], v[216:217], v[14:15]
    v_pk_mul_f32 v[218:219], v[218:219], v[14:15]
    v_pk_mul_f32 v[220:221], v[220:221], v[14:15]
    v_pk_mul_f32 v[222:223], v[222:223], v[14:15]
    v_cvt_pk_bf16_f32 v24, v208, v209
    v_cvt_pk_bf16_f32 v25, v210, v211
    v_cvt_pk_bf16_f32 v26, v212, v213
    v_cvt_pk_bf16_f32 v27, v214, v215
    v_cvt_pk_bf16_f32 v28, v216, v217
    v_cvt_pk_bf16_f32 v29, v218, v219
    v_cvt_pk_bf16_f32 v30, v220, v221
    v_cvt_pk_bf16_f32 v31, v222, v223
    v_cndmask_b32 v30, v30, 0, s[52:53]
    v_cndmask_b32 v31, v31, 0, s[52:53]
    ds_write_b128 v5, v[24:27] offset:2048
    ds_write_b128 v5, v[28:31] offset:3072
    s_mov_b32 s41, 8192
    buffer_load_dwordx4 a[32:35], v4, s[44:47], s41 offen
    s_mov_b32 s41, 9216
    buffer_load_dwordx4 a[36:39], v4, s[44:47], s41 offen
    s_mov_b32 s41, 10240
    buffer_load_dwordx4 a[40:43], v4, s[44:47], s41 offen
    s_mov_b32 s41, 11264
    buffer_load_dwordx4 a[44:47], v4, s[44:47], s41 offen
    s_mov_b32 s41, 12288
    buffer_load_dwordx4 a[48:51], v4, s[44:47], s41 offen
    s_mov_b32 s41, 13312
    buffer_load_dwordx4 a[52:55], v4, s[44:47], s41 offen
    s_mov_b32 s41, 14336
    buffer_load_dwordx4 a[56:59], v4, s[44:47], s41 offen
    s_mov_b32 s41, 15360
    buffer_load_dwordx4 a[60:63], v4, s[44:47], s41 offen
    s_waitcnt vmcnt(16)
    v_mfma_f32_32x32x16_bf16 v[240:255], v[176:179], v[112:115], 0
    v_mfma_f32_32x32x16_bf16 v[240:255], v[180:183], v[116:119], v[240:255]
    v_mfma_f32_32x32x16_bf16 v[240:255], v[184:187], v[120:123], v[240:255]
    v_mfma_f32_32x32x16_bf16 v[240:255], v[188:191], v[124:127], v[240:255]
    v_mov_b32 v12, v236
    v_mov_b32 v13, v236
    s_nop 1
    v_permlane32_swap_b32 v12, v13
    s_nop 1
    v_add_f32 v13, 0x358637bd, v13
    v_rcp_f32 v14, v13
    s_nop 0
    v_mov_b32 v15, v14
    v_pk_mul_f32 v[224:225], v[224:225], v[14:15]
    v_pk_mul_f32 v[226:227], v[226:227], v[14:15]
    v_pk_mul_f32 v[228:229], v[228:229], v[14:15]
    v_pk_mul_f32 v[230:231], v[230:231], v[14:15]
    v_pk_mul_f32 v[232:233], v[232:233], v[14:15]
    v_pk_mul_f32 v[234:235], v[234:235], v[14:15]
    v_pk_mul_f32 v[236:237], v[236:237], v[14:15]
    v_pk_mul_f32 v[238:239], v[238:239], v[14:15]
    v_cvt_pk_bf16_f32 v16, v224, v225
    v_cvt_pk_bf16_f32 v17, v226, v227
    v_cvt_pk_bf16_f32 v18, v228, v229
    v_cvt_pk_bf16_f32 v19, v230, v231
    v_cvt_pk_bf16_f32 v20, v232, v233
    v_cvt_pk_bf16_f32 v21, v234, v235
    v_cvt_pk_bf16_f32 v22, v236, v237
    v_cvt_pk_bf16_f32 v23, v238, v239
    v_cndmask_b32 v22, v22, 0, s[52:53]
    v_cndmask_b32 v23, v23, 0, s[52:53]
    ds_write_b128 v5, v[16:19] offset:4096
    ds_write_b128 v5, v[20:23] offset:5120
    s_mov_b32 s41, 16384
    buffer_load_dwordx4 a[64:67], v4, s[44:47], s41 offen
    s_mov_b32 s41, 17408
    buffer_load_dwordx4 a[68:71], v4, s[44:47], s41 offen
    s_mov_b32 s41, 18432
    buffer_load_dwordx4 a[72:75], v4, s[44:47], s41 offen
    s_mov_b32 s41, 19456
    buffer_load_dwordx4 a[76:79], v4, s[44:47], s41 offen
    s_mov_b32 s41, 20480
    buffer_load_dwordx4 a[80:83], v4, s[44:47], s41 offen
    s_mov_b32 s41, 21504
    buffer_load_dwordx4 a[84:87], v4, s[44:47], s41 offen
    s_mov_b32 s41, 22528
    buffer_load_dwordx4 a[88:91], v4, s[44:47], s41 offen
    s_mov_b32 s41, 23552
    buffer_load_dwordx4 a[92:95], v4, s[44:47], s41 offen
    s_nop 7
    v_mov_b32 v12, v252
    v_mov_b32 v13, v252
    s_nop 1
    v_permlane32_swap_b32 v12, v13
    s_nop 1
    v_add_f32 v13, 0x358637bd, v13
    v_rcp_f32 v14, v13
    s_nop 0
    v_mov_b32 v15, v14
    v_pk_mul_f32 v[240:241], v[240:241], v[14:15]
    v_pk_mul_f32 v[242:243], v[242:243], v[14:15]
    v_pk_mul_f32 v[244:245], v[244:245], v[14:15]
    v_pk_mul_f32 v[246:247], v[246:247], v[14:15]
    v_pk_mul_f32 v[248:249], v[248:249], v[14:15]
    v_pk_mul_f32 v[250:251], v[250:251], v[14:15]
    v_pk_mul_f32 v[252:253], v[252:253], v[14:15]
    v_pk_mul_f32 v[254:255], v[254:255], v[14:15]
    v_cvt_pk_bf16_f32 v24, v240, v241
    v_cvt_pk_bf16_f32 v25, v242, v243
    v_cvt_pk_bf16_f32 v26, v244, v245
    v_cvt_pk_bf16_f32 v27, v246, v247
    v_cvt_pk_bf16_f32 v28, v248, v249
    v_cvt_pk_bf16_f32 v29, v250, v251
    v_cvt_pk_bf16_f32 v30, v252, v253
    v_cvt_pk_bf16_f32 v31, v254, v255
    v_cndmask_b32 v30, v30, 0, s[52:53]
    v_cndmask_b32 v31, v31, 0, s[52:53]
    ds_write_b128 v5, v[24:27] offset:6144
    ds_write_b128 v5, v[28:31] offset:7168
    s_waitcnt lgkmcnt(0)
    s_barrier
    ds_read_b128 v[64:67], v6 offset:0
    ds_read_b128 v[68:71], v6 offset:1024
    ds_read_b128 v[72:75], v6 offset:2048
    ds_read_b128 v[76:79], v6 offset:3072
    ds_read_b128 v[80:83], v6 offset:4096
    ds_read_b128 v[84:87], v6 offset:5120
    ds_read_b128 v[88:91], v6 offset:6144
    ds_read_b128 v[92:95], v6 offset:7168
    s_mov_b32 s41, 24576
    buffer_load_dwordx4 a[96:99], v4, s[44:47], s41 offen
    s_mov_b32 s41, 25600
    buffer_load_dwordx4 a[100:103], v4, s[44:47], s41 offen
    s_mov_b32 s41, 26624
    buffer_load_dwordx4 a[104:107], v4, s[44:47], s41 offen
    s_mov_b32 s41, 27648
    buffer_load_dwordx4 a[108:111], v4, s[44:47], s41 offen
    s_mov_b32 s41, 28672
    buffer_load_dwordx4 a[112:115], v4, s[44:47], s41 offen
    s_mov_b32 s41, 29696
    buffer_load_dwordx4 a[116:119], v4, s[44:47], s41 offen
    s_mov_b32 s41, 30720
    buffer_load_dwordx4 a[120:123], v4, s[44:47], s41 offen
    s_mov_b32 s41, 31744
    buffer_load_dwordx4 a[124:127], v4, s[44:47], s41 offen
    ds_read_b128 v[96:99], v6 offset:8192
    ds_read_b128 v[100:103], v6 offset:9216
    ds_read_b128 v[104:107], v6 offset:10240
    ds_read_b128 v[108:111], v6 offset:11264
    s_waitcnt lgkmcnt(10)
    s_waitcnt vmcnt(30)
    v_mfma_f32_32x32x16_bf16 v[192:207], a[0:3], v[64:67], 0
    v_mfma_f32_32x32x16_bf16 v[192:207], a[4:7], v[68:71], v[192:207]
    ds_read_b128 v[112:115], v6 offset:12288
    ds_read_b128 v[116:119], v6 offset:13312
    s_waitcnt lgkmcnt(10)
    s_waitcnt vmcnt(28)
    v_mfma_f32_32x32x16_bf16 v[192:207], a[8:11], v[72:75], v[192:207]
    v_mfma_f32_32x32x16_bf16 v[192:207], a[12:15], v[76:79], v[192:207]
    ds_read_b128 v[120:123], v6 offset:14336
    ds_read_b128 v[124:127], v6 offset:15360
    s_waitcnt lgkmcnt(10)
    s_waitcnt vmcnt(26)
    v_mfma_f32_32x32x16_bf16 v[192:207], a[16:19], v[80:83], v[192:207]
    v_mfma_f32_32x32x16_bf16 v[192:207], a[20:23], v[84:87], v[192:207]
    ds_read_b128 v[128:131], v6 offset:16384
    ds_read_b128 v[132:135], v6 offset:17408
    s_waitcnt lgkmcnt(10)
    s_waitcnt vmcnt(24)
    v_mfma_f32_32x32x16_bf16 v[192:207], a[24:27], v[88:91], v[192:207]
    v_mfma_f32_32x32x16_bf16 v[192:207], a[28:31], v[92:95], v[192:207]
    ds_read_b128 v[136:139], v6 offset:18432
    ds_read_b128 v[140:143], v6 offset:19456
    s_waitcnt lgkmcnt(10)
    s_waitcnt vmcnt(22)
    v_mfma_f32_32x32x16_bf16 v[192:207], a[32:35], v[96:99], v[192:207]
    v_mfma_f32_32x32x16_bf16 v[192:207], a[36:39], v[100:103], v[192:207]
    ds_read_b128 v[144:147], v6 offset:20480
    ds_read_b128 v[148:151], v6 offset:21504
    s_waitcnt lgkmcnt(10)
    s_waitcnt vmcnt(20)
    v_mfma_f32_32x32x16_bf16 v[192:207], a[40:43], v[104:107], v[192:207]
    v_mfma_f32_32x32x16_bf16 v[192:207], a[44:47], v[108:111], v[192:207]
    ds_read_b128 v[152:155], v6 offset:22528
    ds_read_b128 v[156:159], v6 offset:23552
    s_waitcnt lgkmcnt(10)
    s_waitcnt vmcnt(18)
    v_mfma_f32_32x32x16_bf16 v[192:207], a[48:51], v[112:115], v[192:207]
    v_mfma_f32_32x32x16_bf16 v[192:207], a[52:55], v[116:119], v[192:207]
    ds_read_b128 v[160:163], v6 offset:24576
    ds_read_b128 v[164:167], v6 offset:25600
    s_waitcnt lgkmcnt(10)
    s_waitcnt vmcnt(16)
    v_mfma_f32_32x32x16_bf16 v[192:207], a[56:59], v[120:123], v[192:207]
    v_mfma_f32_32x32x16_bf16 v[192:207], a[60:63], v[124:127], v[192:207]
    ds_read_b128 v[168:171], v6 offset:26624
    ds_read_b128 v[172:175], v6 offset:27648
    s_waitcnt lgkmcnt(10)
    s_waitcnt vmcnt(14)
    v_mfma_f32_32x32x16_bf16 v[192:207], a[64:67], v[128:131], v[192:207]
    v_mfma_f32_32x32x16_bf16 v[192:207], a[68:71], v[132:135], v[192:207]
    ds_read_b128 v[176:179], v6 offset:28672
    ds_read_b128 v[180:183], v6 offset:29696
    s_waitcnt lgkmcnt(10)
    s_waitcnt vmcnt(12)
    v_mfma_f32_32x32x16_bf16 v[192:207], a[72:75], v[136:139], v[192:207]
    v_mfma_f32_32x32x16_bf16 v[192:207], a[76:79], v[140:143], v[192:207]
    ds_read_b128 v[184:187], v6 offset:30720
    ds_read_b128 v[188:191], v6 offset:31744
    s_waitcnt lgkmcnt(10)
    s_waitcnt vmcnt(10)
    v_mfma_f32_32x32x16_bf16 v[192:207], a[80:83], v[144:147], v[192:207]
    v_mfma_f32_32x32x16_bf16 v[192:207], a[84:87], v[148:151], v[192:207]
    s_waitcnt lgkmcnt(8)
    s_waitcnt vmcnt(8)
    v_mfma_f32_32x32x16_bf16 v[192:207], a[88:91], v[152:155], v[192:207]
    v_mfma_f32_32x32x16_bf16 v[192:207], a[92:95], v[156:159], v[192:207]
    s_waitcnt lgkmcnt(6)
    s_waitcnt vmcnt(6)
    v_mfma_f32_32x32x16_bf16 v[192:207], a[96:99], v[160:163], v[192:207]
    v_mfma_f32_32x32x16_bf16 v[192:207], a[100:103], v[164:167], v[192:207]
    s_waitcnt lgkmcnt(4)
    s_waitcnt vmcnt(4)
    v_mfma_f32_32x32x16_bf16 v[192:207], a[104:107], v[168:171], v[192:207]
    v_mfma_f32_32x32x16_bf16 v[192:207], a[108:111], v[172:175], v[192:207]
    s_waitcnt lgkmcnt(2)
    s_waitcnt vmcnt(2)
    v_mfma_f32_32x32x16_bf16 v[192:207], a[112:115], v[176:179], v[192:207]
    v_mfma_f32_32x32x16_bf16 v[192:207], a[116:119], v[180:183], v[192:207]
    s_waitcnt lgkmcnt(0)
    s_waitcnt vmcnt(0)
    v_mfma_f32_32x32x16_bf16 v[192:207], a[120:123], v[184:187], v[192:207]
    v_mfma_f32_32x32x16_bf16 v[192:207], a[124:127], v[188:191], v[192:207]
    s_lshl_b32 s41, s39, 6
    s_nop 7
    s_nop 7
    v_cvt_pk_bf16_f32 v16, v192, v193
    v_cvt_pk_bf16_f32 v17, v194, v195
    v_cvt_pk_bf16_f32 v18, v196, v197
    v_cvt_pk_bf16_f32 v19, v198, v199
    v_cvt_pk_bf16_f32 v20, v200, v201
    v_cvt_pk_bf16_f32 v21, v202, v203
    v_cvt_pk_bf16_f32 v22, v204, v205
    v_cvt_pk_bf16_f32 v23, v206, v207
    s_nop 1
    v_permlane32_swap_b32 v16, v18
    v_permlane32_swap_b32 v17, v19
    v_permlane32_swap_b32 v20, v22
    v_permlane32_swap_b32 v21, v23
    s_nop 1
    s_mul_i32 s42, s38, 2560
    s_add_u32 s42, s42, 91136
    v_and_b32 v12, 31, v1
    v_lshrrev_b32 v13, 5, v1
    v_mul_u32_u24 v12, 80, v12
    v_lshl_add_u32 v12, v13, 4, v12
    v_add_u32 v12, s42, v12
    ds_write_b128 v12, v[16:19]
    ds_write_b128 v12, v[20:23] offset:32
    v_lshrrev_b32 v13, 2, v1
    v_and_b32 v14, 3, v1
    v_mul_u32_u24 v15, 80, v13
    v_lshl_add_u32 v15, v14, 4, v15
    v_add_u32 v15, s42, v15
    s_lshl_b32 s42, s36, 5
    v_add_u32 v13, s42, v13
    v_mul_u32_u24 v7, 1792, v13
    v_lshl_add_u32 v7, v14, 4, v7
    s_add_u32 s42, s41, 28672
    s_waitcnt lgkmcnt(0)
    ds_read_b128 v[32:35], v15
    ds_read_b128 v[36:39], v15 offset:1280
    s_waitcnt lgkmcnt(1)
    buffer_store_dwordx4 v[32:35], v7, s[48:51], s41 offen
    s_waitcnt lgkmcnt(0)
    buffer_store_dwordx4 v[36:39], v7, s[48:51], s42 offen
    s_branch L2_e_3
L2_pB_1:
    s_mov_b32 s41, 8192
    buffer_load_dwordx4 v[160:163], v3, s[44:47], s41 offen
    buffer_load_dwordx4 v[96:99], v2, s[44:47], s41 offen
    s_mov_b32 s41, 9216
    buffer_load_dwordx4 v[164:167], v3, s[44:47], s41 offen
    buffer_load_dwordx4 v[100:103], v2, s[44:47], s41 offen
    s_mov_b32 s41, 10240
    buffer_load_dwordx4 v[168:171], v3, s[44:47], s41 offen
    buffer_load_dwordx4 v[104:107], v2, s[44:47], s41 offen
    s_mov_b32 s41, 11264
    buffer_load_dwordx4 v[172:175], v3, s[44:47], s41 offen
    buffer_load_dwordx4 v[108:111], v2, s[44:47], s41 offen
    s_waitcnt vmcnt(16)
    v_mfma_f32_32x32x16_bf16 v[192:207], v[128:131], v[64:67], 0
    v_mfma_f32_32x32x16_bf16 v[192:207], v[132:135], v[68:71], v[192:207]
    v_mfma_f32_32x32x16_bf16 v[192:207], v[136:139], v[72:75], v[192:207]
    v_mfma_f32_32x32x16_bf16 v[192:207], v[140:143], v[76:79], v[192:207]
    s_mov_b32 s41, 12288
    buffer_load_dwordx4 v[176:179], v3, s[44:47], s41 offen
    buffer_load_dwordx4 v[112:115], v2, s[44:47], s41 offen
    s_mov_b32 s41, 13312
    buffer_load_dwordx4 v[180:183], v3, s[44:47], s41 offen
    buffer_load_dwordx4 v[116:119], v2, s[44:47], s41 offen
    s_mov_b32 s41, 14336
    buffer_load_dwordx4 v[184:187], v3, s[44:47], s41 offen
    buffer_load_dwordx4 v[120:123], v2, s[44:47], s41 offen
    s_mov_b32 s41, 15360
    buffer_load_dwordx4 v[188:191], v3, s[44:47], s41 offen
    buffer_load_dwordx4 v[124:127], v2, s[44:47], s41 offen
    s_waitcnt vmcnt(16)
    v_mfma_f32_32x32x16_bf16 v[208:223], v[144:147], v[80:83], 0
    v_mfma_f32_32x32x16_bf16 v[208:223], v[148:151], v[84:87], v[208:223]
    v_mfma_f32_32x32x16_bf16 v[208:223], v[152:155], v[88:91], v[208:223]
    v_mfma_f32_32x32x16_bf16 v[208:223], v[156:159], v[92:95], v[208:223]
    v_mov_b32 v12, v204
    v_mov_b32 v13, v204
    s_nop 1
    v_permlane32_swap_b32 v12, v13
    s_nop 1
    v_add_f32 v13, 0x358637bd, v13
    v_rcp_f32 v14, v13
    s_nop 0
    v_mov_b32 v15, v14
    v_pk_mul_f32 v[192:193], v[192:193], v[14:15]
    v_pk_mul_f32 v[194:195], v[194:195], v[14:15]
    v_pk_mul_f32 v[196:197], v[196:197], v[14:15]
    v_pk_mul_f32 v[198:199], v[198:199], v[14:15]
    v_pk_mul_f32 v[200:201], v[200:201], v[14:15]
    v_pk_mul_f32 v[202:203], v[202:203], v[14:15]
    v_pk_mul_f32 v[204:205], v[204:205], v[14:15]
    v_pk_mul_f32 v[206:207], v[206:207], v[14:15]
    v_cvt_pk_bf16_f32 v16, v192, v193
    v_cvt_pk_bf16_f32 v17, v194, v195
    v_cvt_pk_bf16_f32 v18, v196, v197
    v_cvt_pk_bf16_f32 v19, v198, v199
    v_cvt_pk_bf16_f32 v20, v200, v201
    v_cvt_pk_bf16_f32 v21, v202, v203
    v_cvt_pk_bf16_f32 v22, v204, v205
    v_cvt_pk_bf16_f32 v23, v206, v207
    v_cndmask_b32 v22, v22, 0, s[52:53]
    v_cndmask_b32 v23, v23, 0, s[52:53]
    ds_write_b128 v5, v[16:19] offset:0
    ds_write_b128 v5, v[20:23] offset:1024
    s_mov_b32 s41, 0
    buffer_load_dwordx4 a[0:3], v8, s[44:47], s41 offen
    s_mov_b32 s41, 1024
    buffer_load_dwordx4 a[4:7], v8, s[44:47], s41 offen
    s_mov_b32 s41, 2048
    buffer_load_dwordx4 a[8:11], v8, s[44:47], s41 offen
    s_mov_b32 s41, 3072
    buffer_load_dwordx4 a[12:15], v8, s[44:47], s41 offen
    s_mov_b32 s41, 4096
    buffer_load_dwordx4 a[16:19], v8, s[44:47], s41 offen
    s_mov_b32 s41, 5120
    buffer_load_dwordx4 a[20:23], v8, s[44:47], s41 offen
    s_mov_b32 s41, 6144
    buffer_load_dwordx4 a[24:27], v8, s[44:47], s41 offen
    s_mov_b32 s41, 7168
    buffer_load_dwordx4 a[28:31], v8, s[44:47], s41 offen
    s_waitcnt vmcnt(16)
    v_mfma_f32_32x32x16_bf16 v[224:239], v[160:163], v[96:99], 0
    v_mfma_f32_32x32x16_bf16 v[224:239], v[164:167], v[100:103], v[224:239]
    v_mfma_f32_32x32x16_bf16 v[224:239], v[168:171], v[104:107], v[224:239]
    v_mfma_f32_32x32x16_bf16 v[224:239], v[172:175], v[108:111], v[224:239]
    v_mov_b32 v12, v220
    v_mov_b32 v13, v220
    s_nop 1
    v_permlane32_swap_b32 v12, v13
    s_nop 1
    v_add_f32 v13, 0x358637bd, v13
    v_rcp_f32 v14, v13
    s_nop 0
    v_mov_b32 v15, v14
    v_pk_mul_f32 v[208:209], v[208:209], v[14:15]
    v_pk_mul_f32 v[210:211], v[210:211], v[14:15]
    v_pk_mul_f32 v[212:213], v[212:213], v[14:15]
    v_pk_mul_f32 v[214:215], v[214:215], v[14:15]
    v_pk_mul_f32 v[216:217], v[216:217], v[14:15]
    v_pk_mul_f32 v[218:219], v[218:219], v[14:15]
    v_pk_mul_f32 v[220:221], v[220:221], v[14:15]
    v_pk_mul_f32 v[222:223], v[222:223], v[14:15]
    v_cvt_pk_bf16_f32 v24, v208, v209
    v_cvt_pk_bf16_f32 v25, v210, v211
    v_cvt_pk_bf16_f32 v26, v212, v213
    v_cvt_pk_bf16_f32 v27, v214, v215
    v_cvt_pk_bf16_f32 v28, v216, v217
    v_cvt_pk_bf16_f32 v29, v218, v219
    v_cvt_pk_bf16_f32 v30, v220, v221
    v_cvt_pk_bf16_f32 v31, v222, v223
    v_cndmask_b32 v30, v30, 0, s[52:53]
    v_cndmask_b32 v31, v31, 0, s[52:53]
    ds_write_b128 v5, v[24:27] offset:2048
    ds_write_b128 v5, v[28:31] offset:3072
    s_mov_b32 s41, 8192
    buffer_load_dwordx4 a[32:35], v8, s[44:47], s41 offen
    s_mov_b32 s41, 9216
    buffer_load_dwordx4 a[36:39], v8, s[44:47], s41 offen
    s_mov_b32 s41, 10240
    buffer_load_dwordx4 a[40:43], v8, s[44:47], s41 offen
    s_mov_b32 s41, 11264
    buffer_load_dwordx4 a[44:47], v8, s[44:47], s41 offen
    s_mov_b32 s41, 12288
    buffer_load_dwordx4 a[48:51], v8, s[44:47], s41 offen
    s_mov_b32 s41, 13312
    buffer_load_dwordx4 a[52:55], v8, s[44:47], s41 offen
    s_waitcnt vmcnt(14)
    v_mfma_f32_32x32x16_bf16 v[240:255], v[176:179], v[112:115], 0
    v_mfma_f32_32x32x16_bf16 v[240:255], v[180:183], v[116:119], v[240:255]
    v_mfma_f32_32x32x16_bf16 v[240:255], v[184:187], v[120:123], v[240:255]
    v_mfma_f32_32x32x16_bf16 v[240:255], v[188:191], v[124:127], v[240:255]
    v_mov_b32 v12, v236
    v_mov_b32 v13, v236
    s_nop 1
    v_permlane32_swap_b32 v12, v13
    s_nop 1
    v_add_f32 v13, 0x358637bd, v13
    v_rcp_f32 v14, v13
    s_nop 0
    v_mov_b32 v15, v14
    v_pk_mul_f32 v[224:225], v[224:225], v[14:15]
    v_pk_mul_f32 v[226:227], v[226:227], v[14:15]
    v_pk_mul_f32 v[228:229], v[228:229], v[14:15]
    v_pk_mul_f32 v[230:231], v[230:231], v[14:15]
    v_pk_mul_f32 v[232:233], v[232:233], v[14:15]
    v_pk_mul_f32 v[234:235], v[234:235], v[14:15]
    v_pk_mul_f32 v[236:237], v[236:237], v[14:15]
    v_pk_mul_f32 v[238:239], v[238:239], v[14:15]
    v_cvt_pk_bf16_f32 v16, v224, v225
    v_cvt_pk_bf16_f32 v17, v226, v227
    v_cvt_pk_bf16_f32 v18, v228, v229
    v_cvt_pk_bf16_f32 v19, v230, v231
    v_cvt_pk_bf16_f32 v20, v232, v233
    v_cvt_pk_bf16_f32 v21, v234, v235
    v_cvt_pk_bf16_f32 v22, v236, v237
    v_cvt_pk_bf16_f32 v23, v238, v239
    v_cndmask_b32 v22, v22, 0, s[52:53]
    v_cndmask_b32 v23, v23, 0, s[52:53]
    ds_write_b128 v5, v[16:19] offset:4096
    ds_write_b128 v5, v[20:23] offset:5120
    s_nop 7
    v_mov_b32 v12, v252
    v_mov_b32 v13, v252
    s_nop 1
    v_permlane32_swap_b32 v12, v13
    s_nop 1
    v_add_f32 v13, 0x358637bd, v13
    v_rcp_f32 v14, v13
    s_nop 0
    v_mov_b32 v15, v14
    v_pk_mul_f32 v[240:241], v[240:241], v[14:15]
    v_pk_mul_f32 v[242:243], v[242:243], v[14:15]
    v_pk_mul_f32 v[244:245], v[244:245], v[14:15]
    v_pk_mul_f32 v[246:247], v[246:247], v[14:15]
    v_pk_mul_f32 v[248:249], v[248:249], v[14:15]
    v_pk_mul_f32 v[250:251], v[250:251], v[14:15]
    v_pk_mul_f32 v[252:253], v[252:253], v[14:15]
    v_pk_mul_f32 v[254:255], v[254:255], v[14:15]
    v_cvt_pk_bf16_f32 v24, v240, v241
    v_cvt_pk_bf16_f32 v25, v242, v243
    v_cvt_pk_bf16_f32 v26, v244, v245
    v_cvt_pk_bf16_f32 v27, v246, v247
    v_cvt_pk_bf16_f32 v28, v248, v249
    v_cvt_pk_bf16_f32 v29, v250, v251
    v_cvt_pk_bf16_f32 v30, v252, v253
    v_cvt_pk_bf16_f32 v31, v254, v255
    v_cndmask_b32 v30, v30, 0, s[52:53]
    v_cndmask_b32 v31, v31, 0, s[52:53]
    ds_write_b128 v5, v[24:27] offset:6144
    ds_write_b128 v5, v[28:31] offset:7168
    s_waitcnt lgkmcnt(0)
    s_barrier
    s_sub_u32 s42, s38, 2
    s_mul_i32 s41, s42, 14336
    s_add_u32 s41, s41, 32768
    v_lshl_add_u32 v9, v1, 4, s41
    v_lshrrev_b32 v12, 4, v1
    v_and_b32 v13, 1, v12
    v_lshrrev_b32 v12, 1, v12
    v_bfe_u32 v14, v1, 2, 2
    v_lshl_add_u32 v14, v12, 3, v14
    v_lshlrev_b32 v14, 6, v14
    v_lshl_add_u32 v14, v13, 5, v14
    v_and_b32 v15, 3, v1
    v_lshl_add_u32 v14, v15, 3, v14
    v_add_u32 v10, s41, v14
    v_and_b32 v14, 15, v1
    v_lshl_add_u32 v14, v13, 4, v14
    s_lshl_b32 s41, s36, 5
    v_add_u32 v14, s41, v14
    v_mul_u32_u24 v7, 1792, v14
    v_lshl_add_u32 v7, v12, 4, v7
    s_mul_i32 s41, s42, 448
    s_add_u32 s41, s41, 896
    s_waitcnt vmcnt(0)
    ds_write_b128 v9, a[0:3] offset:0
    ds_write_b128 v9, a[4:7] offset:1024
    ds_write_b128 v9, a[8:11] offset:2048
    ds_write_b128 v9, a[12:15] offset:3072
    ds_write_b128 v9, a[16:19] offset:4096
    ds_write_b128 v9, a[20:23] offset:5120
    ds_write_b128 v9, a[24:27] offset:6144
    ds_write_b128 v9, a[28:31] offset:7168
    ds_write_b128 v9, a[32:35] offset:8192
    ds_write_b128 v9, a[36:39] offset:9216
    ds_write_b128 v9, a[40:43] offset:10240
    ds_write_b128 v9, a[44:47] offset:11264
    ds_write_b128 v9, a[48:51] offset:12288
    ds_write_b128 v9, a[52:55] offset:13312
    s_waitcnt lgkmcnt(0)
    ds_read_b64_tr_b16 v[64:65], v10 offset:0
    ds_read_b64_tr_b16 v[66:67], v10 offset:256
    ds_read_b64_tr_b16 v[68:69], v10 offset:1024
    ds_read_b64_tr_b16 v[70:71], v10 offset:1280
    ds_read_b64_tr_b16 v[72:73], v10 offset:2048
    ds_read_b64_tr_b16 v[74:75], v10 offset:2304
    ds_read_b64_tr_b16 v[76:77], v10 offset:3072
    ds_read_b64_tr_b16 v[78:79], v10 offset:3328
    ds_read_b64_tr_b16 v[80:81], v10 offset:4096
    ds_read_b64_tr_b16 v[82:83], v10 offset:4352
    ds_read_b64_tr_b16 v[84:85], v10 offset:5120
    ds_read_b64_tr_b16 v[86:87], v10 offset:5376
    ds_read_b64_tr_b16 v[88:89], v10 offset:6144
    ds_read_b64_tr_b16 v[90:91], v10 offset:6400
    ds_read_b64_tr_b16 v[92:93], v10 offset:7168
    ds_read_b64_tr_b16 v[94:95], v10 offset:7424
    ds_read_b64_tr_b16 v[96:97], v10 offset:8192
    ds_read_b64_tr_b16 v[98:99], v10 offset:8448
    ds_read_b64_tr_b16 v[100:101], v10 offset:9216
    ds_read_b64_tr_b16 v[102:103], v10 offset:9472
    ds_read_b64_tr_b16 v[104:105], v10 offset:10240
    ds_read_b64_tr_b16 v[106:107], v10 offset:10496
    ds_read_b64_tr_b16 v[108:109], v10 offset:11264
    ds_read_b64_tr_b16 v[110:111], v10 offset:11520
    ds_read_b64_tr_b16 v[112:113], v10 offset:12288
    ds_read_b64_tr_b16 v[114:115], v10 offset:12544
    ds_read_b64_tr_b16 v[116:117], v10 offset:13312
    ds_read_b64_tr_b16 v[118:119], v10 offset:13568
    s_sub_u32 s42, s38, 2
    s_mul_i32 s43, s42, 14848
    s_add_u32 s43, s43, 61440
    v_and_b32 v12, 31, v1
    v_lshrrev_b32 v13, 5, v1
    v_mul_u32_u24 v14, 464, v12
    v_lshl_add_u32 v14, v13, 4, v14
    v_add_u32 v14, s43, v14
    v_mul_u32_u24 v15, 464, v13
    v_lshl_add_u32 v15, v12, 4, v15
    v_add_u32 v15, s43, v15
    s_lshl_b32 s43, s36, 5
    v_add_u32 v13, s43, v13
    v_mul_u32_u24 v7, 1792, v13
    v_lshl_add_u32 v7, v12, 4, v7
    s_waitcnt lgkmcnt(15)
    ds_write_b128 v14, v[64:67] offset:0
    s_waitcnt lgkmcnt(15)
    ds_write_b128 v14, v[68:71] offset:32
    s_waitcnt lgkmcnt(15)
    ds_write_b128 v14, v[72:75] offset:64
    s_waitcnt lgkmcnt(15)
    ds_write_b128 v14, v[76:79] offset:96
    s_waitcnt lgkmcnt(15)
    ds_write_b128 v14, v[80:83] offset:128
    s_waitcnt lgkmcnt(15)
    ds_write_b128 v14, v[84:87] offset:160
    s_waitcnt lgkmcnt(15)
    ds_write_b128 v14, v[88:91] offset:192
    s_waitcnt lgkmcnt(15)
    ds_write_b128 v14, v[92:95] offset:224
    s_waitcnt lgkmcnt(15)
    ds_write_b128 v14, v[96:99] offset:256
    s_waitcnt lgkmcnt(15)
    ds_write_b128 v14, v[100:103] offset:288
    s_waitcnt lgkmcnt(15)
    ds_write_b128 v14, v[104:107] offset:320
    s_waitcnt lgkmcnt(15)
    ds_write_b128 v14, v[108:111] offset:352
    s_waitcnt lgkmcnt(14)
    ds_write_b128 v14, v[112:115] offset:384
    s_waitcnt lgkmcnt(13)
    ds_write_b128 v14, v[116:119] offset:416
    s_waitcnt lgkmcnt(0)
    s_mov_b32 exec_lo, 0x0fffffff
    s_mov_b32 exec_hi, 0x0fffffff
    ds_read_b128 v[128:131], v15 offset:0
    ds_read_b128 v[132:135], v15 offset:928
    ds_read_b128 v[136:139], v15 offset:1856
    ds_read_b128 v[140:143], v15 offset:2784
    ds_read_b128 v[144:147], v15 offset:3712
    ds_read_b128 v[148:151], v15 offset:4640
    ds_read_b128 v[152:155], v15 offset:5568
    ds_read_b128 v[156:159], v15 offset:6496
    ds_read_b128 v[160:163], v15 offset:7424
    ds_read_b128 v[164:167], v15 offset:8352
    ds_read_b128 v[168:171], v15 offset:9280
    ds_read_b128 v[172:175], v15 offset:10208
    ds_read_b128 v[176:179], v15 offset:11136
    ds_read_b128 v[180:183], v15 offset:12064
    ds_read_b128 v[184:187], v15 offset:12992
    ds_read_b128 v[188:191], v15 offset:13920
    s_add_u32 s43, s41, 0
    s_waitcnt lgkmcnt(15)
    buffer_store_dwordx4 v[128:131], v7, s[48:51], s43 offen
    s_add_u32 s43, s41, 3584
    s_waitcnt lgkmcnt(14)
    buffer_store_dwordx4 v[132:135], v7, s[48:51], s43 offen
    s_add_u32 s43, s41, 7168
    s_waitcnt lgkmcnt(13)
    buffer_store_dwordx4 v[136:139], v7, s[48:51], s43 offen
    s_add_u32 s43, s41, 10752
    s_waitcnt lgkmcnt(12)
    buffer_store_dwordx4 v[140:143], v7, s[48:51], s43 offen
    s_add_u32 s43, s41, 14336
    s_waitcnt lgkmcnt(11)
    buffer_store_dwordx4 v[144:147], v7, s[48:51], s43 offen
    s_add_u32 s43, s41, 17920
    s_waitcnt lgkmcnt(10)
    buffer_store_dwordx4 v[148:151], v7, s[48:51], s43 offen
    s_add_u32 s43, s41, 21504
    s_waitcnt lgkmcnt(9)
    buffer_store_dwordx4 v[152:155], v7, s[48:51], s43 offen
    s_add_u32 s43, s41, 25088
    s_waitcnt lgkmcnt(8)
    buffer_store_dwordx4 v[156:159], v7, s[48:51], s43 offen
    s_add_u32 s43, s41, 28672
    s_waitcnt lgkmcnt(7)
    buffer_store_dwordx4 v[160:163], v7, s[48:51], s43 offen
    s_add_u32 s43, s41, 32256
    s_waitcnt lgkmcnt(6)
    buffer_store_dwordx4 v[164:167], v7, s[48:51], s43 offen
    s_add_u32 s43, s41, 35840
    s_waitcnt lgkmcnt(5)
    buffer_store_dwordx4 v[168:171], v7, s[48:51], s43 offen
    s_add_u32 s43, s41, 39424
    s_waitcnt lgkmcnt(4)
    buffer_store_dwordx4 v[172:175], v7, s[48:51], s43 offen
    s_add_u32 s43, s41, 43008
    s_waitcnt lgkmcnt(3)
    buffer_store_dwordx4 v[176:179], v7, s[48:51], s43 offen
    s_add_u32 s43, s41, 46592
    s_waitcnt lgkmcnt(2)
    buffer_store_dwordx4 v[180:183], v7, s[48:51], s43 offen
    s_add_u32 s43, s41, 50176
    s_waitcnt lgkmcnt(1)
    buffer_store_dwordx4 v[184:187], v7, s[48:51], s43 offen
    s_add_u32 s43, s41, 53760
    s_waitcnt lgkmcnt(0)
    buffer_store_dwordx4 v[188:191], v7, s[48:51], s43 offen
    s_mov_b64 exec, -1
L2_e_3:
L2_END:
    s_endpgm
.section .rodata,"a"
.p2align 6
.amdhsa_kernel l1_kernel
  .amdhsa_next_free_vgpr 256
  .amdhsa_next_free_sgpr 102
  .amdhsa_accum_offset 256
  .amdhsa_group_segment_fixed_size 0
  .amdhsa_kernarg_size 128
  .amdhsa_user_sgpr_count 2
  .amdhsa_user_sgpr_kernarg_segment_ptr 1
  .amdhsa_system_sgpr_workgroup_id_x 1
.end_amdhsa_kernel
.p2align 6
.amdhsa_kernel l2_kernel
  .amdhsa_next_free_vgpr 512
  .amdhsa_next_free_sgpr 102
  .amdhsa_accum_offset 256
  .amdhsa_group_segment_fixed_size 0
  .amdhsa_kernarg_size 128
  .amdhsa_user_sgpr_count 2
  .amdhsa_user_sgpr_kernarg_segment_ptr 1
  .amdhsa_system_sgpr_workgroup_id_x 1
.end_amdhsa_kernel
```
